```python
import torch

def _softmax(x, axis=-1):
    return torch.softmax(x, dim=axis)
def _gelu(x):
    return torch.nn.functional.gelu(x, approximate="tanh")
def _silu(x):
    return torch.nn.functional.silu(x)
def _sigmoid(x):
    return torch.sigmoid(x)
def _layernorm(x, axis=-1, eps=1e-5):
    m = x.mean(dim=axis, keepdim=True)
    v = x.var(dim=axis, keepdim=True, unbiased=False)
    return (x - m) / torch.sqrt(v + eps)
def _scatter_add(tgt, idx, src, axis=0):
    return tgt.clone().index_add_(axis, idx, src)
def _segment_sum(src, seg, n):
    out = torch.zeros((n,) + src.shape[1:], dtype=src.dtype)
    return out.index_add_(0, seg, src)
def _pad(x, pw):
    flat = tuple(v for pair in reversed(pw) for v in pair)
    return torch.nn.functional.pad(x, flat)

kernel_name = 'recurrent_scan__spectral_gfnet__glu_gated_glu__prompt'

def setup_inputs():

    _w = (lambda a: (lambda t: t.to(torch.bfloat16) if t.is_floating_point() else t)(torch.as_tensor(a)))
    def _A_setup():
        B, S, D = 1, 2048, 448
        Df = D // 2 + 1
        return {
            "x": _w((lambda *s: torch.randn(*s, dtype=torch.bfloat16) * 0.05)(B, S, D)),
            "w_r": _w((lambda *s: torch.randn(*s, dtype=torch.bfloat16) * 0.2)(S, Df) * 0.02),
            "w_i": _w((lambda *s: torch.randn(*s, dtype=torch.bfloat16) * 0.2)(S, Df) * 0.02),
        }
    _A_in = _A_setup()

    def _B_setup():
        B, S, D, F = 1, 2048, 448, 1792
        return {
            "x": _w((lambda *s: torch.randn(*s, dtype=torch.bfloat16) * 0.05)(B, S, D)),
            "w_gate": _w((lambda *s: torch.randn(*s, dtype=torch.bfloat16) * 0.2)(D, F)),
            "w_up": _w((lambda *s: torch.randn(*s, dtype=torch.bfloat16) * 0.1)(D, F)),
            "w_down": _w((lambda *s: torch.randn(*s, dtype=torch.bfloat16) * 0.1)(F, D)),
        }
    _B_in = _B_setup()

    return {
        "A_x": _A_in["x"],
        "A_w_r": _A_in["w_r"],
        "A_w_i": _A_in["w_i"],
        "B_x": _B_in["x"],
        "B_w_gate": _B_in["w_gate"],
        "B_w_up": _B_in["w_up"],
        "B_w_down": _B_in["w_down"],
    }

def reference(A_x, A_w_r, A_w_i, B_x, B_w_gate, B_w_up, B_w_down):
    def _A_ref(x, w_r, w_i):
        B, S, D = x.shape
        X = (lambda x, axes=(-2,-1): torch.fft.rfft2(x.float(), dim=axes))(x, axes=(-2, -1))
        W = w_r + 1j * w_i
        X = X * W
        y = (lambda x, s, axes=(-2,-1): torch.fft.irfft2(x, s=s, dim=axes).to(torch.bfloat16))(X, (S, D), axes=(-2, -1))
        return y

    def _B_ref(x, w_gate, w_up, w_down):
        g = torch.einsum("bsd,df->bsf", x, w_gate)
        u = torch.einsum("bsd,df->bsf", x, w_up)
        h = _sigmoid(g) * u
        return torch.einsum("bsf,fd->bsd", h, w_down)

    x = A_x
    xn = _layernorm(x, axis=-1)
    s = _A_ref(xn, A_w_r, A_w_i)
    g = _silu(_B_ref(xn, B_w_gate, B_w_up, B_w_down))
    return x + s * g
```

```asm
; @launch grid=(256,1,1) block=(256,1,1) lds=163840
.amdgcn_target "amdgcn-amd-amdhsa--gfx950"
.text
.globl recurrent_scan__spectral_gfnet__glu_gated_glu__prompt_kernel
.p2align 12
.p2align 8
.type recurrent_scan__spectral_gfnet__glu_gated_glu__prompt_kernel,@function
recurrent_scan__spectral_gfnet__glu_gated_glu__prompt_kernel:
    s_cmp_ge_u32 s2, 256
    s_cbranch_scc1 L_done
    s_load_dwordx2 s[20:21], s[0:1], 72
    v_lshrrev_b32 v1, 6, v0
    s_and_b32 s50, s2, 7
    v_readfirstlane_b32 s3, v1
    s_lshr_b32 s51, s2, 3
    s_cmp_ge_u32 s51, 28
    s_cbranch_scc1 L_f2
    s_load_dwordx2 s[4:5], s[0:1], 0
    s_load_dwordx2 s[16:17], s[0:1], 48
    s_load_dwordx2 s[8:9], s[0:1], 32
    s_load_dwordx2 s[12:13], s[0:1], 40
    s_load_dwordx2 s[24:25], s[0:1], 56
    v_and_b32 v0, 63, v0
    s_getpc_b64 s[68:69]
    v_min_u32 v1, 23, v0
    v_lshlrev_b32 v1, 7, v1
    global_load_dword a249, v1, s[68:69] offset:384
    s_lshr_b32 s0, s51, 2
    s_and_b32 s44, s51, 3
    s_and_b32 s45, s50, 1
    s_and_b32 s28, s50, 6
    s_lshl1_add_u32 s28, s28, s44
    s_mul_i32 s29, s45, 7
    s_add_u32 s29, s29, s0
    s_lshl1_add_u32 s1, s28, s45
    s_and_b32 s32, s3, 1
    s_lshr_b32 s33, s3, 1
    s_mov_b32 s66, s0
    s_lshl_b32 s46, s66, 7
    v_lshrrev_b32 v1, 4, v0
    v_and_b32 v7, 7, v0
    v_xor_b32 v2, v7, v1
    s_lshl_b32 s67, s32, 4
    v_add_u32 v3, s67, v1
    v_sub_u32 v4, 64, v3
    v_bfe_u32 v5, v0, 3, 1
    v_cmp_eq_u32 vcc, 1, v5
    v_mov_b32 v6, 114688
    v_mov_b32 v8, 4294852608
    v_cndmask_b32 v3, v3, v4, vcc
    v_cndmask_b32 v6, v6, v8, vcc
    v_cmp_eq_u32_e64 vcc, 64, v3
    v_mul_u32_u24 v4, 28672, v3
    s_lshl1_add_u32 s67, s28, s33
    v_cndmask_b32 v3, v3, 32, vcc
    s_mul_i32 s67, s67, 896
    v_lshl_add_u32 v8, v2, 4, s67
    v_xor_b32 v9, 64, v8
    v_mul_u32_u24 v3, 28672, v3
    v_add_u32 v10, 3072, v8
    v_add_u32_e64 v10, v10, v3
    v_add3_u32 v11, v4, v6, v9
    v_lshl_add_u32 v12, v6, 1, v4
    v_add3_u32 v13, v12, v6, v9
    v_add_u32 v11, 2048, v11
    v_add_u32_e64 v12, v12, v8
    v_add_u32 v12, 1024, v12
    s_mul_i32 s65, s3, 28672
    s_add_u32 s65, s65, 49152
    s_mov_b32 s6, 1838080
    s_mov_b32 s7, 0x00020000
    s_waitcnt lgkmcnt(0)
    s_sub_u32 s4, s4, 3072
    s_subb_u32 s5, s5, 0
    s_add_u32 m0, s65, 0
    s_nop 0
    buffer_load_dwordx4 v10, s[4:7], s46 offen offset:0 lds
    buffer_load_dwordx4 v11, s[4:7], s46 offen offset:1024 lds
    s_load_dword s36, s[20:21], 0
    s_lshl_b32 s67, s66, 2
    s_mov_b32 s68, 0x06543210
    s_mov_b32 s69, 0x00054321
    s_lshr_b64 s[68:69], s[68:69], s67
    s_bfe_u32 s47, s68, 262148
    s_lshl_b32 s47, s47, 7
    s_bfe_u32 s48, s68, 262152
    s_lshl_b32 s48, s48, 7
    s_bfe_u32 s49, s68, 262156
    s_lshl_b32 s49, s49, 7
    s_nop 0
    s_bfe_u32 s50, s68, 262160
    s_lshl_b32 s50, s50, 7
    s_bfe_u32 s51, s68, 262164
    s_lshl_b32 s51, s51, 7
    s_bfe_u32 s52, s68, 262168
    s_lshl_b32 s52, s52, 7
    v_and_b32 v1, 31, v0
    v_bfe_u32 v2, v1, 2, 1
    v_lshrrev_b32 v3, 3, v1
    v_and_b32 v4, 3, v1
    v_lshl_add_u32 v4, v3, 2, v4
    v_lshl_add_u32 v30, v2, 4, v4
    s_lshr_b32 s67, s29, 1
    s_lshl_b32 s67, s67, 5
    v_add_u32 v4, s67, v30
    v_lshlrev_b32 v26, 31, v4
    v_or_b32 v26, 1.0, v26
    s_and_b32 s67, s29, 1
    v_cvt_f32_u32 v5, s67
    v_mul_f32 v5, 0x3e800000, v5
    s_xor_b32 s67, s67, 1
    v_or_b32 v2, s67, v4
    v_cmp_eq_u32 vcc, 0, v2
    v_mov_b32 v3, 224
    v_lshrrev_b32 v2, 5, v0
    v_cndmask_b32 v4, v4, v3, vcc
    v_cndmask_b32 v5, v5, 0, vcc
    v_cvt_f32_u32_e64 v4, v4
    v_mul_f32 v4, 0x3b124925, v4
    v_lshl_add_u32 v2, s66, 3, v2
    v_cvt_f32_u32 v2, v2
    v_mul_f32 v3, 0x41000000, v4
    buffer_load_dwordx4 v12, s[4:7], s46 offen offset:2048 lds
    v_fract_f32 v3, v3
    v_mul_f32 v2, v2, v3
    v_fract_f32 v2, v2
    v_add_f32 v5, v5, v2
    v_mul_f32 v6, 0x41800000, v4
    v_fract_f32 v6, v6
    v_add_f32 v2, v4, v4
    v_cos_f32 v3, v6
    v_cos_f32 v2, v2
    v_add_f32 v6, v6, v5
    v_add_f32 v3, v3, v3
    v_add_f32 v2, v2, v2
    v_add_f32_e64 v241, v4, v5
    v_fma_f32 v242, v4, 2.0, v5
    v_fmamk_f32 v243, v4, 0x40400000, v5
    v_cos_f32 v240, v5
    v_cos_f32 v241, v241
    v_cos_f32 v242, v242
    v_cos_f32 v243, v243
    v_add_f32_e64 v249, v4, v6
    buffer_load_dwordx4 v13, s[4:7], s46 offen offset:3072 lds
    v_fma_f32 v250, v4, 2.0, v6
    v_fmamk_f32 v251, v4, 0x40400000, v6
    v_cos_f32 v248, v6
    v_cos_f32 v249, v249
    v_cos_f32 v250, v250
    v_cos_f32 v251, v251
    v_pk_fma_f32 v[244:245], v[242:243], v[2:3], v[240:241] op_sel:[0,0,0] op_sel_hi:[1,0,1] neg_lo:[0,0,1] neg_hi:[0,0,1]
    v_pk_fma_f32 v[252:253], v[250:251], v[2:3], v[248:249] op_sel:[0,0,0] op_sel_hi:[1,0,1] neg_lo:[0,0,1] neg_hi:[0,0,1]
    v_pk_fma_f32 v[246:247], v[244:245], v[2:3], v[242:243] op_sel:[0,0,0] op_sel_hi:[1,0,1] neg_lo:[0,0,1] neg_hi:[0,0,1]
    v_pk_fma_f32 v[254:255], v[252:253], v[2:3], v[250:251] op_sel:[0,0,0] op_sel_hi:[1,0,1] neg_lo:[0,0,1] neg_hi:[0,0,1]
    v_cvt_pk_bf16_f32 v32, v240, v241
    v_cvt_pk_bf16_f32 v33, v242, v243
    v_cvt_pk_bf16_f32 v34, v244, v245
    v_cvt_pk_bf16_f32 v35, v246, v247
    v_cvt_pk_bf16_f32 v36, v248, v249
    v_cvt_pk_bf16_f32 v37, v250, v251
    v_cvt_pk_bf16_f32 v38, v252, v253
    v_cvt_pk_bf16_f32 v39, v254, v255
    v_pk_fma_f32 v[240:241], v[248:249], v[2:3], v[240:241] op_sel:[0,1,0] op_sel_hi:[1,1,1] neg_lo:[0,0,1] neg_hi:[0,0,1]
    v_pk_fma_f32 v[242:243], v[250:251], v[2:3], v[242:243] op_sel:[0,1,0] op_sel_hi:[1,1,1] neg_lo:[0,0,1] neg_hi:[0,0,1]
    v_pk_fma_f32 v[244:245], v[252:253], v[2:3], v[244:245] op_sel:[0,1,0] op_sel_hi:[1,1,1] neg_lo:[0,0,1] neg_hi:[0,0,1]
    v_pk_fma_f32 v[246:247], v[254:255], v[2:3], v[246:247] op_sel:[0,1,0] op_sel_hi:[1,1,1] neg_lo:[0,0,1] neg_hi:[0,0,1]
    v_cvt_pk_bf16_f32 v40, v240, v241
    v_cvt_pk_bf16_f32 v41, v242, v243
    v_cvt_pk_bf16_f32 v42, v244, v245
    v_cvt_pk_bf16_f32 v43, v246, v247
    v_pk_fma_f32 v[248:249], v[240:241], v[2:3], v[248:249] op_sel:[0,1,0] op_sel_hi:[1,1,1] neg_lo:[0,0,1] neg_hi:[0,0,1]
    v_pk_fma_f32 v[250:251], v[242:243], v[2:3], v[250:251] op_sel:[0,1,0] op_sel_hi:[1,1,1] neg_lo:[0,0,1] neg_hi:[0,0,1]
    v_pk_fma_f32 v[252:253], v[244:245], v[2:3], v[252:253] op_sel:[0,1,0] op_sel_hi:[1,1,1] neg_lo:[0,0,1] neg_hi:[0,0,1]
    v_pk_fma_f32 v[254:255], v[246:247], v[2:3], v[254:255] op_sel:[0,1,0] op_sel_hi:[1,1,1] neg_lo:[0,0,1] neg_hi:[0,0,1]
    v_cvt_pk_bf16_f32 v44, v248, v249
    v_cvt_pk_bf16_f32 v45, v250, v251
    v_cvt_pk_bf16_f32 v46, v252, v253
    v_cvt_pk_bf16_f32 v47, v254, v255
    v_pk_fma_f32 v[240:241], v[248:249], v[2:3], v[240:241] op_sel:[0,1,0] op_sel_hi:[1,1,1] neg_lo:[0,0,1] neg_hi:[0,0,1]
    v_pk_fma_f32 v[242:243], v[250:251], v[2:3], v[242:243] op_sel:[0,1,0] op_sel_hi:[1,1,1] neg_lo:[0,0,1] neg_hi:[0,0,1]
    v_pk_fma_f32 v[244:245], v[252:253], v[2:3], v[244:245] op_sel:[0,1,0] op_sel_hi:[1,1,1] neg_lo:[0,0,1] neg_hi:[0,0,1]
    v_pk_fma_f32 v[246:247], v[254:255], v[2:3], v[246:247] op_sel:[0,1,0] op_sel_hi:[1,1,1] neg_lo:[0,0,1] neg_hi:[0,0,1]
    v_cvt_pk_bf16_f32 v48, v240, v241
    v_cvt_pk_bf16_f32 v49, v242, v243
    v_cvt_pk_bf16_f32 v50, v244, v245
    v_cvt_pk_bf16_f32 v51, v246, v247
    v_pk_fma_f32 v[248:249], v[240:241], v[2:3], v[248:249] op_sel:[0,1,0] op_sel_hi:[1,1,1] neg_lo:[0,0,1] neg_hi:[0,0,1]
    v_pk_fma_f32 v[250:251], v[242:243], v[2:3], v[250:251] op_sel:[0,1,0] op_sel_hi:[1,1,1] neg_lo:[0,0,1] neg_hi:[0,0,1]
    v_pk_fma_f32 v[252:253], v[244:245], v[2:3], v[252:253] op_sel:[0,1,0] op_sel_hi:[1,1,1] neg_lo:[0,0,1] neg_hi:[0,0,1]
    v_pk_fma_f32 v[254:255], v[246:247], v[2:3], v[254:255] op_sel:[0,1,0] op_sel_hi:[1,1,1] neg_lo:[0,0,1] neg_hi:[0,0,1]
    v_cvt_pk_bf16_f32 v52, v248, v249
    v_cvt_pk_bf16_f32 v53, v250, v251
    v_cvt_pk_bf16_f32 v54, v252, v253
    v_cvt_pk_bf16_f32 v55, v254, v255
    v_pk_fma_f32 v[240:241], v[248:249], v[2:3], v[240:241] op_sel:[0,1,0] op_sel_hi:[1,1,1] neg_lo:[0,0,1] neg_hi:[0,0,1]
    v_pk_fma_f32 v[242:243], v[250:251], v[2:3], v[242:243] op_sel:[0,1,0] op_sel_hi:[1,1,1] neg_lo:[0,0,1] neg_hi:[0,0,1]
    v_pk_fma_f32 v[244:245], v[252:253], v[2:3], v[244:245] op_sel:[0,1,0] op_sel_hi:[1,1,1] neg_lo:[0,0,1] neg_hi:[0,0,1]
    v_pk_fma_f32 v[246:247], v[254:255], v[2:3], v[246:247] op_sel:[0,1,0] op_sel_hi:[1,1,1] neg_lo:[0,0,1] neg_hi:[0,0,1]
    v_cvt_pk_bf16_f32 v56, v240, v241
    v_cvt_pk_bf16_f32 v57, v242, v243
    v_cvt_pk_bf16_f32 v58, v244, v245
    v_cvt_pk_bf16_f32 v59, v246, v247
    v_pk_fma_f32 v[248:249], v[240:241], v[2:3], v[248:249] op_sel:[0,1,0] op_sel_hi:[1,1,1] neg_lo:[0,0,1] neg_hi:[0,0,1]
    v_pk_fma_f32 v[250:251], v[242:243], v[2:3], v[250:251] op_sel:[0,1,0] op_sel_hi:[1,1,1] neg_lo:[0,0,1] neg_hi:[0,0,1]
    v_pk_fma_f32 v[252:253], v[244:245], v[2:3], v[252:253] op_sel:[0,1,0] op_sel_hi:[1,1,1] neg_lo:[0,0,1] neg_hi:[0,0,1]
    v_pk_fma_f32 v[254:255], v[246:247], v[2:3], v[254:255] op_sel:[0,1,0] op_sel_hi:[1,1,1] neg_lo:[0,0,1] neg_hi:[0,0,1]
    v_cvt_pk_bf16_f32 v60, v248, v249
    v_cvt_pk_bf16_f32 v61, v250, v251
    v_cvt_pk_bf16_f32 v62, v252, v253
    v_cvt_pk_bf16_f32 v63, v254, v255
    v_pk_fma_f32 v[240:241], v[248:249], v[2:3], v[240:241] op_sel:[0,1,0] op_sel_hi:[1,1,1] neg_lo:[0,0,1] neg_hi:[0,0,1]
    v_pk_fma_f32 v[242:243], v[250:251], v[2:3], v[242:243] op_sel:[0,1,0] op_sel_hi:[1,1,1] neg_lo:[0,0,1] neg_hi:[0,0,1]
    v_pk_fma_f32 v[244:245], v[252:253], v[2:3], v[244:245] op_sel:[0,1,0] op_sel_hi:[1,1,1] neg_lo:[0,0,1] neg_hi:[0,0,1]
    v_pk_fma_f32 v[246:247], v[254:255], v[2:3], v[246:247] op_sel:[0,1,0] op_sel_hi:[1,1,1] neg_lo:[0,0,1] neg_hi:[0,0,1]
    v_cvt_pk_bf16_f32 v64, v240, v241
    v_cvt_pk_bf16_f32 v65, v242, v243
    v_cvt_pk_bf16_f32 v66, v244, v245
    v_cvt_pk_bf16_f32 v67, v246, v247
    v_pk_fma_f32 v[248:249], v[240:241], v[2:3], v[248:249] op_sel:[0,1,0] op_sel_hi:[1,1,1] neg_lo:[0,0,1] neg_hi:[0,0,1]
    v_pk_fma_f32 v[250:251], v[242:243], v[2:3], v[250:251] op_sel:[0,1,0] op_sel_hi:[1,1,1] neg_lo:[0,0,1] neg_hi:[0,0,1]
    v_pk_fma_f32 v[252:253], v[244:245], v[2:3], v[252:253] op_sel:[0,1,0] op_sel_hi:[1,1,1] neg_lo:[0,0,1] neg_hi:[0,0,1]
    v_pk_fma_f32 v[254:255], v[246:247], v[2:3], v[254:255] op_sel:[0,1,0] op_sel_hi:[1,1,1] neg_lo:[0,0,1] neg_hi:[0,0,1]
    v_cvt_pk_bf16_f32 v68, v248, v249
    v_cvt_pk_bf16_f32 v69, v250, v251
    v_cvt_pk_bf16_f32 v70, v252, v253
    v_cvt_pk_bf16_f32 v71, v254, v255
    v_pk_fma_f32 v[240:241], v[248:249], v[2:3], v[240:241] op_sel:[0,1,0] op_sel_hi:[1,1,1] neg_lo:[0,0,1] neg_hi:[0,0,1]
    v_pk_fma_f32 v[242:243], v[250:251], v[2:3], v[242:243] op_sel:[0,1,0] op_sel_hi:[1,1,1] neg_lo:[0,0,1] neg_hi:[0,0,1]
    v_pk_fma_f32 v[244:245], v[252:253], v[2:3], v[244:245] op_sel:[0,1,0] op_sel_hi:[1,1,1] neg_lo:[0,0,1] neg_hi:[0,0,1]
    s_add_u32 m0, s65, 4096
    s_nop 0
    buffer_load_dwordx4 v10, s[4:7], s47 offen offset:0 lds
    v_pk_fma_f32 v[246:247], v[254:255], v[2:3], v[246:247] op_sel:[0,1,0] op_sel_hi:[1,1,1] neg_lo:[0,0,1] neg_hi:[0,0,1]
    s_nop 0
    v_cvt_pk_bf16_f32 v72, v240, v241
    v_cvt_pk_bf16_f32 v73, v242, v243
    v_cvt_pk_bf16_f32 v74, v244, v245
    v_cvt_pk_bf16_f32 v75, v246, v247
    v_pk_fma_f32 v[248:249], v[240:241], v[2:3], v[248:249] op_sel:[0,1,0] op_sel_hi:[1,1,1] neg_lo:[0,0,1] neg_hi:[0,0,1]
    v_pk_fma_f32 v[250:251], v[242:243], v[2:3], v[250:251] op_sel:[0,1,0] op_sel_hi:[1,1,1] neg_lo:[0,0,1] neg_hi:[0,0,1]
    v_pk_fma_f32 v[252:253], v[244:245], v[2:3], v[252:253] op_sel:[0,1,0] op_sel_hi:[1,1,1] neg_lo:[0,0,1] neg_hi:[0,0,1]
    v_pk_fma_f32 v[254:255], v[246:247], v[2:3], v[254:255] op_sel:[0,1,0] op_sel_hi:[1,1,1] neg_lo:[0,0,1] neg_hi:[0,0,1]
    v_cvt_pk_bf16_f32 v76, v248, v249
    v_cvt_pk_bf16_f32 v77, v250, v251
    v_cvt_pk_bf16_f32 v78, v252, v253
    v_cvt_pk_bf16_f32 v79, v254, v255
    v_pk_fma_f32 v[240:241], v[248:249], v[2:3], v[240:241] op_sel:[0,1,0] op_sel_hi:[1,1,1] neg_lo:[0,0,1] neg_hi:[0,0,1]
    v_pk_fma_f32 v[242:243], v[250:251], v[2:3], v[242:243] op_sel:[0,1,0] op_sel_hi:[1,1,1] neg_lo:[0,0,1] neg_hi:[0,0,1]
    v_pk_fma_f32 v[244:245], v[252:253], v[2:3], v[244:245] op_sel:[0,1,0] op_sel_hi:[1,1,1] neg_lo:[0,0,1] neg_hi:[0,0,1]
    v_pk_fma_f32 v[246:247], v[254:255], v[2:3], v[246:247] op_sel:[0,1,0] op_sel_hi:[1,1,1] neg_lo:[0,0,1] neg_hi:[0,0,1]
    v_cvt_pk_bf16_f32 v80, v240, v241
    v_cvt_pk_bf16_f32 v81, v242, v243
    buffer_load_dwordx4 v11, s[4:7], s47 offen offset:1024 lds
    v_cvt_pk_bf16_f32 v82, v244, v245
    v_cvt_pk_bf16_f32 v83, v246, v247
    v_pk_fma_f32 v[248:249], v[240:241], v[2:3], v[248:249] op_sel:[0,1,0] op_sel_hi:[1,1,1] neg_lo:[0,0,1] neg_hi:[0,0,1]
    v_pk_fma_f32 v[250:251], v[242:243], v[2:3], v[250:251] op_sel:[0,1,0] op_sel_hi:[1,1,1] neg_lo:[0,0,1] neg_hi:[0,0,1]
    v_pk_fma_f32 v[252:253], v[244:245], v[2:3], v[252:253] op_sel:[0,1,0] op_sel_hi:[1,1,1] neg_lo:[0,0,1] neg_hi:[0,0,1]
    v_pk_fma_f32 v[254:255], v[246:247], v[2:3], v[254:255] op_sel:[0,1,0] op_sel_hi:[1,1,1] neg_lo:[0,0,1] neg_hi:[0,0,1]
    v_cvt_pk_bf16_f32 v84, v248, v249
    v_cvt_pk_bf16_f32 v85, v250, v251
    v_cvt_pk_bf16_f32 v86, v252, v253
    v_cvt_pk_bf16_f32 v87, v254, v255
    s_mov_b32 s67, 0x3f803f80
    v_mov_b32_e64 v1, s67
    v_accvgpr_write_b32 a252, v1
    v_accvgpr_write_b32 a253, v1
    v_accvgpr_write_b32 a254, v1
    v_accvgpr_write_b32 a255, v1
    s_nop 1
    s_nop 0
    v_mfma_f32_32x32x16_bf16 v[240:255], a[252:255], v[32:35], 0
    buffer_load_dwordx4 v12, s[4:7], s47 offen offset:2048 lds
    v_and_b32 v1, 31, v0
    v_lshrrev_b32 v4, 5, v0
    v_bfe_u32 v3, v0, 1, 3
    v_xor_b32 v2, v4, v3
    v_lshlrev_b32 v2, 4, v2
    v_mfma_f32_32x32x16_bf16 v[240:255], a[252:255], v[36:39], v[240:255]
    v_lshl_add_u32 v2, v1, 7, v2
    v_add_u32 v128, s65, v2
    v_xor_b32 v129, 32, v128
    v_xor_b32 v130, 64, v128
    v_xor_b32 v131, 96, v128
    v_mov_b32 v22, 0
    v_mfma_f32_32x32x16_bf16 v[240:255], a[252:255], v[40:43], v[240:255]
    buffer_load_dwordx4 v13, s[4:7], s47 offen offset:3072 lds
    v_mov_b32 v23, 0
    v_lshrrev_b32 v3, 3, v0
    v_and_b32 v2, 2, v3
    v_lshlrev_b32 v2, 1, v2
    v_xor_b32_e64 v5, v7, v2
    v_mfma_f32_32x32x16_bf16 v[240:255], a[252:255], v[44:47], v[240:255]
    v_mul_u32_u24 v1, 896, v3
    v_lshl_add_u32 v18, v5, 4, v1
    v_add_u32 v19, 6144, v18
    s_lshl2_add_u32 s62, s1, s3
    s_mul_i32 s60, s62, 14336
    s_lshl_b32 s40, s0, 7
    v_mfma_f32_32x32x16_bf16 v[240:255], a[252:255], v[48:51], v[240:255]
    s_add_u32 m0, s65, 8192
    s_nop 0
    buffer_load_dwordx4 v10, s[4:7], s48 offen offset:0 lds
    s_add_u32 s60, s60, s40
    s_lshl_b32 s34, s3, 12
    s_lshl_b32 s43, s3, 11
    s_add_u32 s43, s43, 49152
    v_mfma_f32_32x32x16_bf16 v[240:255], a[252:255], v[52:55], v[240:255]
    s_mov_b32 s18, 1605632
    s_mov_b32 s19, 0x00020000
    v_xor_b32 v6, 2, v5
    s_mul_i32 s40, s3, 57344
    s_lshl_b32 s41, s29, 8
    s_add_u32 s40, s40, s41
    v_mfma_f32_32x32x16_bf16 v[240:255], a[252:255], v[56:59], v[240:255]
    buffer_load_dwordx4 v11, s[4:7], s48 offen offset:1024 lds
    v_mul_u32_u24 v1, 3584, v3
    v_add_u32 v1, s40, v1
    v_lshl_add_u32 v14, v5, 4, v1
    v_lshl_add_u32 v16, v6, 4, v1
    v_add_u32 v15, 27648, v14
    v_mfma_f32_32x32x16_bf16 v[240:255], a[252:255], v[60:63], v[240:255]
    v_add_u32 v17, 27648, v16
    s_cmp_eq_u32 s33, 0
    s_cselect_b64 s[26:27], s[8:9], s[12:13]
    s_mul_i32 s40, s28, 100352
    s_add_u32 s40, s40, s41
    s_mul_i32 s41, s32, 128
    v_mfma_f32_32x32x16_bf16 v[240:255], a[252:255], v[64:67], v[240:255]
    buffer_load_dwordx4 v12, s[4:7], s48 offen offset:2048 lds
    s_add_u32 s40, s40, s41
    v_min_u32_e64 v27, 27, v0
    v_mul_u32_u24 v27, 3584, v27
    v_add_u32_e64 v27, s40, v27
    s_mov_b32 s10, 1605632
    v_mfma_f32_32x32x16_bf16 v[240:255], a[252:255], v[68:71], v[240:255]
    s_mov_b32 s11, 0x00020000
    s_sub_u32 s12, s12, 2048
    s_subb_u32 s13, s13, 0
    s_mov_b32 s14, 1607680
    s_nop 0
    s_mov_b32 s15, 0x00020000
    s_mul_i32 s53, s46, 896
    v_mfma_f32_32x32x16_bf16 v[240:255], a[252:255], v[72:75], v[240:255]
    buffer_load_dwordx4 v13, s[4:7], s48 offen offset:3072 lds
    s_mul_i32 s54, s47, 896
    s_mul_i32 s55, s48, 896
    s_mul_i32 s56, s49, 896
    s_mul_i32 s57, s50, 896
    s_mul_i32 s58, s51, 896
    s_mov_b64 exec, 0
    s_cmp_eq_u32 s3, 0
    s_cbranch_scc1 L_padg0
    s_cmp_eq_u32 s3, 1
    s_cbranch_scc1 L_padg1
    s_cmp_eq_u32 s3, 2
    s_cbranch_scc1 L_padg2
    s_branch L_padg3
L_padg5:
L_padg6:
L_padg7:
L_padg8:
L_hbg:
    s_mov_b64 exec, -1
    s_nop 3
    v_mfma_f32_32x32x16_bf16 v[240:255], a[252:255], v[76:79], v[240:255]
    s_waitcnt vmcnt(8)
    s_nop 0
    ds_read_b128 v[144:147], v128 offset:0
    ds_read_b128 v[148:151], v129 offset:0
    ds_read_b128 v[152:155], v130 offset:0
    ds_read_b128 v[156:159], v131 offset:0
    s_mul_i32 s59, s52, 896
    v_mfma_f32_32x32x16_bf16 v[240:255], a[252:255], v[80:83], v[240:255]
    s_add_u32 m0, s65, 12288
    s_nop 0
    buffer_load_dwordx4 v10, s[4:7], s49 offen offset:0 lds
    v_mfma_f32_32x32x16_bf16 v[240:255], a[252:255], v[84:87], v[240:255]
    s_waitcnt lgkmcnt(0)
    v_mfma_f32_32x32x16_bf16 v[96:111], v[144:147], v[32:35], 0
    buffer_load_dwordx4 v11, s[4:7], s49 offen offset:1024 lds
    v_mfma_f32_32x32x16_bf16 v[96:111], v[148:151], v[36:39], v[96:111]
    buffer_load_dwordx4 v12, s[4:7], s49 offen offset:2048 lds
    v_mfma_f32_32x32x16_bf16 v[96:111], v[152:155], v[40:43], v[96:111]
    buffer_load_dwordx4 v13, s[4:7], s49 offen offset:3072 lds
    v_cmp_gt_u32 vcc, 32, v0
    s_nop 3
    v_fma_f32 v1, v240, v26, v240
    v_and_b32 v2, 0xffff0000, v1
    v_sub_f32_e64 v1, v1, v2
    v_cvt_pk_bf16_f32 v1, v2, v1
    v_mfma_f32_32x32x16_bf16 v[96:111], v[156:159], v[44:47], v[96:111]
    s_waitcnt vmcnt(8)
    ds_read_b128 v[160:163], v128 offset:4096
    s_nop 0
    ds_read_b128 v[164:167], v129 offset:4096
    ds_read_b128 v[168:171], v130 offset:4096
    ds_read_b128 v[172:175], v131 offset:4096
    s_add_u32 m0, s65, 16384
    s_nop 0
    buffer_load_dwordx4 v10, s[4:7], s50 offen offset:0 lds
    v_cndmask_b32 v1, 0, v1, vcc
    v_accvgpr_write_b32 a200, v1
    v_dot2c_f32_bf16 v22, s67, v144
    v_dot2c_f32_bf16 v23, v144, v144
    v_dot2c_f32_bf16 v22, s67, v145
    v_dot2c_f32_bf16 v23, v145, v145
    v_dot2c_f32_bf16 v22, s67, v146
    v_dot2c_f32_bf16 v23, v146, v146
    v_dot2c_f32_bf16 v22, s67, v147
    v_dot2c_f32_bf16 v23, v147, v147
    v_dot2c_f32_bf16 v22, s67, v148
    v_dot2c_f32_bf16 v23, v148, v148
    v_dot2c_f32_bf16 v22, s67, v149
    v_dot2c_f32_bf16 v23, v149, v149
    v_dot2c_f32_bf16 v22, s67, v150
    v_dot2c_f32_bf16 v23, v150, v150
    v_dot2c_f32_bf16 v22, s67, v151
    v_dot2c_f32_bf16 v23, v151, v151
    v_dot2c_f32_bf16 v22, s67, v152
    v_dot2c_f32_bf16 v23, v152, v152
    v_dot2c_f32_bf16 v22, s67, v153
    v_dot2c_f32_bf16 v23, v153, v153
    v_dot2c_f32_bf16 v22, s67, v154
    v_dot2c_f32_bf16 v23, v154, v154
    v_dot2c_f32_bf16 v22, s67, v155
    v_dot2c_f32_bf16 v23, v155, v155
    v_dot2c_f32_bf16 v22, s67, v156
    v_dot2c_f32_bf16 v23, v156, v156
    v_dot2c_f32_bf16 v22, s67, v157
    v_dot2c_f32_bf16 v23, v157, v157
    v_dot2c_f32_bf16 v22, s67, v158
    v_dot2c_f32_bf16 v23, v158, v158
    v_dot2c_f32_bf16 v22, s67, v159
    v_dot2c_f32_bf16 v23, v159, v159
    s_waitcnt lgkmcnt(0)
    s_nop 0
    v_mfma_f32_32x32x16_bf16 v[96:111], v[160:163], v[48:51], v[96:111]
    buffer_load_dwordx4 v11, s[4:7], s50 offen offset:1024 lds
    v_accvgpr_write_b32 a193, 0
    v_accvgpr_write_b32 a194, 0
    v_accvgpr_write_b32 a195, 0
    v_accvgpr_write_b32 a197, 0
    v_accvgpr_write_b32 a198, 0
    v_mfma_f32_32x32x16_bf16 v[96:111], v[164:167], v[52:55], v[96:111]
    buffer_load_dwordx4 v12, s[4:7], s50 offen offset:2048 lds
    v_accvgpr_write_b32 a199, 0
    v_accvgpr_write_b32 a201, 0
    v_accvgpr_write_b32 a202, 0
    v_accvgpr_write_b32 a203, 0
    v_and_b32 v9, 31, v0
    v_mfma_f32_32x32x16_bf16 v[96:111], v[168:171], v[56:59], v[96:111]
    buffer_load_dwordx4 v13, s[4:7], s50 offen offset:3072 lds
    v_lshlrev_b32 v8, 2, v4
    v_sub_u32 v8, v9, v8
    v_and_b32 v9, 1, v8
    v_lshlrev_b32 v9, 4, v9
    v_mov_b32 v1, 0x3f80
    v_mfma_f32_32x32x16_bf16 v[96:111], v[172:175], v[60:63], v[96:111]
    s_waitcnt vmcnt(8)
    ds_read_b128 v[176:179], v128 offset:8192
    ds_read_b128 v[180:183], v129 offset:8192
    ds_read_b128 v[184:187], v130 offset:8192
    ds_read_b128 v[188:191], v131 offset:8192
    s_add_u32 m0, s65, 20480
    s_nop 0
    buffer_load_dwordx4 v10, s[4:7], s51 offen offset:0 lds
    v_lshlrev_b32 v9, v9, v1
    v_and_b32 v8, -2, v8
    v_dot2c_f32_bf16 v22, s67, v160
    v_dot2c_f32_bf16 v23, v160, v160
    v_dot2c_f32_bf16 v22, s67, v161
    v_dot2c_f32_bf16 v23, v161, v161
    v_dot2c_f32_bf16 v22, s67, v162
    v_dot2c_f32_bf16 v23, v162, v162
    v_dot2c_f32_bf16 v22, s67, v163
    v_dot2c_f32_bf16 v23, v163, v163
    v_dot2c_f32_bf16 v22, s67, v164
    v_dot2c_f32_bf16 v23, v164, v164
    v_dot2c_f32_bf16 v22, s67, v165
    v_dot2c_f32_bf16 v23, v165, v165
    v_dot2c_f32_bf16 v22, s67, v166
    v_dot2c_f32_bf16 v23, v166, v166
    v_dot2c_f32_bf16 v22, s67, v167
    v_dot2c_f32_bf16 v23, v167, v167
    v_dot2c_f32_bf16 v22, s67, v168
    v_dot2c_f32_bf16 v23, v168, v168
    v_dot2c_f32_bf16 v22, s67, v169
    v_dot2c_f32_bf16 v23, v169, v169
    v_dot2c_f32_bf16 v22, s67, v170
    v_dot2c_f32_bf16 v23, v170, v170
    v_dot2c_f32_bf16 v22, s67, v171
    v_dot2c_f32_bf16 v23, v171, v171
    v_dot2c_f32_bf16 v22, s67, v172
    v_dot2c_f32_bf16 v23, v172, v172
    v_dot2c_f32_bf16 v22, s67, v173
    v_dot2c_f32_bf16 v23, v173, v173
    v_dot2c_f32_bf16 v22, s67, v174
    v_dot2c_f32_bf16 v23, v174, v174
    v_dot2c_f32_bf16 v22, s67, v175
    v_dot2c_f32_bf16 v23, v175, v175
    s_waitcnt lgkmcnt(0)
    v_mfma_f32_32x32x16_bf16 v[96:111], v[176:179], v[64:67], v[96:111]
    buffer_load_dwordx4 v11, s[4:7], s51 offen offset:1024 lds
    v_cmp_eq_u32 s[40:41], 0, v8
    v_cmp_eq_u32 s[68:69], 2, v8
    v_cmp_eq_u32_e64 vcc, 8, v8
    v_cndmask_b32 v1, 0, v9, s[40:41]
    v_accvgpr_write_b32 a240, v1
    v_mfma_f32_32x32x16_bf16 v[96:111], v[180:183], v[68:71], v[96:111]
    buffer_load_dwordx4 v12, s[4:7], s51 offen offset:2048 lds
    v_cmp_eq_u32 s[40:41], 10, v8
    v_cndmask_b32 v1, 0, v9, s[68:69]
    v_accvgpr_write_b32 a241, v1
    v_cmp_eq_u32 s[68:69], 16, v8
    v_cndmask_b32_e64 v1, 0, v9, vcc
    v_mfma_f32_32x32x16_bf16 v[96:111], v[184:187], v[72:75], v[96:111]
    buffer_load_dwordx4 v13, s[4:7], s51 offen offset:3072 lds
    v_accvgpr_write_b32 a242, v1
    v_cmp_eq_u32_e64 vcc, 18, v8
    v_cndmask_b32 v1, 0, v9, s[40:41]
    v_accvgpr_write_b32 a243, v1
    v_cmp_eq_u32 s[40:41], 24, v8
    v_mfma_f32_32x32x16_bf16 v[96:111], v[188:191], v[76:79], v[96:111]
    s_waitcnt vmcnt(8)
    ds_read_b128 v[192:195], v128 offset:12288
    s_nop 0
    ds_read_b128 v[196:199], v129 offset:12288
    ds_read_b128 v[200:203], v130 offset:12288
    ds_read_b128 v[204:207], v131 offset:12288
    s_add_u32 m0, s65, 24576
    s_nop 0
    buffer_load_dwordx4 v10, s[4:7], s52 offen offset:0 lds
    v_cndmask_b32 v1, 0, v9, s[68:69]
    v_accvgpr_write_b32 a244, v1
    v_dot2c_f32_bf16 v22, s67, v176
L_padg0:
    s_cbranch_execz L_padg4
    v_dot2c_f32_bf16 v23, v176, v176
    v_dot2c_f32_bf16 v22, s67, v177
    v_dot2c_f32_bf16 v23, v177, v177
    v_dot2c_f32_bf16 v22, s67, v178
    v_dot2c_f32_bf16 v23, v178, v178
    v_dot2c_f32_bf16 v22, s67, v179
    v_dot2c_f32_bf16 v23, v179, v179
    v_dot2c_f32_bf16 v22, s67, v180
    v_dot2c_f32_bf16 v23, v180, v180
    v_dot2c_f32_bf16 v22, s67, v181
    v_dot2c_f32_bf16 v23, v181, v181
    v_dot2c_f32_bf16 v22, s67, v182
    v_dot2c_f32_bf16 v23, v182, v182
    v_dot2c_f32_bf16 v22, s67, v183
    v_dot2c_f32_bf16 v23, v183, v183
    v_dot2c_f32_bf16 v22, s67, v184
    v_dot2c_f32_bf16 v23, v184, v184
    v_dot2c_f32_bf16 v22, s67, v185
    v_dot2c_f32_bf16 v23, v185, v185
    v_dot2c_f32_bf16 v22, s67, v186
    v_dot2c_f32_bf16 v23, v186, v186
    v_dot2c_f32_bf16 v22, s67, v187
    v_dot2c_f32_bf16 v23, v187, v187
    v_dot2c_f32_bf16 v22, s67, v188
    v_dot2c_f32_bf16 v23, v188, v188
    v_dot2c_f32_bf16 v22, s67, v189
    v_dot2c_f32_bf16 v23, v189, v189
    v_dot2c_f32_bf16 v22, s67, v190
    v_dot2c_f32_bf16 v23, v190, v190
    v_dot2c_f32_bf16 v22, s67, v191
    v_dot2c_f32_bf16 v23, v191, v191
    s_waitcnt lgkmcnt(0)
    v_mfma_f32_32x32x16_bf16 v[96:111], v[192:195], v[80:83], v[96:111]
    buffer_load_dwordx4 v11, s[4:7], s52 offen offset:1024 lds
    v_cmp_eq_u32 s[68:69], 26, v8
    v_cndmask_b32 v1, 0, v9, vcc
    v_accvgpr_write_b32 a245, v1
    v_cndmask_b32 v1, 0, v9, s[40:41]
    v_accvgpr_write_b32 a246, v1
    v_mfma_f32_32x32x16_bf16 v[96:111], v[196:199], v[84:87], v[96:111]
    buffer_load_dwordx4 v12, s[4:7], s52 offen offset:2048 lds
    v_cndmask_b32 v1, 0, v9, s[68:69]
    v_accvgpr_write_b32 a247, v1
    s_mul_i32 s42, s28, 4224
    v_lshlrev_b32_e64 v24, 4, v0
    s_mov_b32 s22, 268435456
    v_mfma_f32_32x32x16_bf16 v[112:127], v[200:203], v[32:35], 0
    buffer_load_dwordx4 v13, s[4:7], s52 offen offset:3072 lds
    s_mov_b32 s23, 0x00020000
    v_add_u32_e64 v20, s43, v24
    v_add_u32 v20, 8192, v20
    v_xor_b32 v21, 2048, v20
    v_bfe_u32 v3, v0, 4, 1
    v_mfma_f32_32x32x16_bf16 v[112:127], v[204:207], v[36:39], v[112:127]
    s_waitcnt vmcnt(8)
    ds_read_b128 v[208:211], v128 offset:16384
    ds_read_b128 v[212:215], v129 offset:16384
    ds_read_b128 v[216:219], v130 offset:16384
    ds_read_b128 v[220:223], v131 offset:16384
    s_barrier
    s_mov_b32 m0, s43
    s_nop 0
    buffer_load_dwordx4 v18, s[16:19], s60 offen nt lds
    v_bfe_u32 v5, v0, 2, 2
    v_dot2c_f32_bf16 v22, s67, v192
    v_dot2c_f32_bf16 v23, v192, v192
    v_dot2c_f32_bf16 v22, s67, v193
    v_dot2c_f32_bf16 v23, v193, v193
    v_dot2c_f32_bf16 v22, s67, v194
    v_dot2c_f32_bf16 v23, v194, v194
    v_dot2c_f32_bf16 v22, s67, v195
    v_dot2c_f32_bf16 v23, v195, v195
    v_dot2c_f32_bf16 v22, s67, v196
    v_dot2c_f32_bf16 v23, v196, v196
    v_dot2c_f32_bf16 v22, s67, v197
    v_dot2c_f32_bf16 v23, v197, v197
    v_dot2c_f32_bf16 v22, s67, v198
    v_dot2c_f32_bf16 v23, v198, v198
    v_dot2c_f32_bf16 v22, s67, v199
    v_dot2c_f32_bf16 v23, v199, v199
    v_dot2c_f32_bf16 v22, s67, v200
    v_dot2c_f32_bf16 v23, v200, v200
    v_dot2c_f32_bf16 v22, s67, v201
    v_dot2c_f32_bf16 v23, v201, v201
    v_dot2c_f32_bf16 v22, s67, v202
    v_dot2c_f32_bf16 v23, v202, v202
    v_dot2c_f32_bf16 v22, s67, v203
    v_dot2c_f32_bf16 v23, v203, v203
    v_dot2c_f32_bf16 v22, s67, v204
    v_dot2c_f32_bf16 v23, v204, v204
    v_dot2c_f32_bf16 v22, s67, v205
    v_dot2c_f32_bf16 v23, v205, v205
    v_dot2c_f32_bf16 v22, s67, v206
    v_dot2c_f32_bf16 v23, v206, v206
    v_dot2c_f32_bf16 v22, s67, v207
    v_dot2c_f32_bf16 v23, v207, v207
    s_waitcnt lgkmcnt(0)
    v_mfma_f32_32x32x16_bf16 v[112:127], v[208:211], v[40:43], v[112:127]
    s_nop 0
    buffer_load_dwordx4 v19, s[16:19], s60 offen offset:1024 nt lds
    v_and_b32 v6, 3, v0
    v_lshl_add_u32 v1, v4, 2, v5
    v_lshlrev_b32 v1, 7, v1
    v_lshl_add_u32 v2, v3, 2, v6
    v_and_b32 v7, 1, v2
    v_mfma_f32_32x32x16_bf16 v[112:127], v[212:215], v[44:47], v[112:127]
    global_load_dword a248, v27, s[26:27] offset:0
    v_lshrrev_b32 v2, 1, v2
    v_lshl_add_u32 v2, v7, 2, v2
    v_and_b32 v7, 2, v5
    v_lshlrev_b32 v7, 2, v7
    v_xor_b32 v2, v2, v7
    v_mfma_f32_32x32x16_bf16 v[112:127], v[216:219], v[48:51], v[112:127]
    v_lshl_add_u32 v1, v2, 3, v1
    v_add_u32 v29, s43, v1
    s_lshr_b32 s61, s62, 3
    s_lshl_b32 s61, s61, 11
    s_bfe_u32 s40, s62, 131073
    s_lshl3_add_u32 s40, s0, s40
    v_mfma_f32_32x32x16_bf16 v[112:127], v[220:223], v[52:55], v[112:127]
    s_waitcnt vmcnt(7)
    ds_read_b128 v[224:227], v128 offset:20480
    ds_read_b128 v[228:231], v129 offset:20480
    ds_read_b128 v[232:235], v130 offset:20480
    ds_read_b128 v[236:239], v131 offset:20480
    s_mul_i32 s40, s40, 28672
    s_add_u32 s61, s61, s40
    s_lshl_b32 s40, s32, 10
    s_add_u32 s61, s61, s40
    v_dot2c_f32_bf16 v22, s67, v208
    v_dot2c_f32_bf16 v23, v208, v208
    v_dot2c_f32_bf16 v22, s67, v209
    v_dot2c_f32_bf16 v23, v209, v209
    v_dot2c_f32_bf16 v22, s67, v210
    v_dot2c_f32_bf16 v23, v210, v210
    v_dot2c_f32_bf16 v22, s67, v211
    v_dot2c_f32_bf16 v23, v211, v211
    v_dot2c_f32_bf16 v22, s67, v212
    v_dot2c_f32_bf16 v23, v212, v212
    v_dot2c_f32_bf16 v22, s67, v213
    v_dot2c_f32_bf16 v23, v213, v213
    v_dot2c_f32_bf16 v22, s67, v214
    v_dot2c_f32_bf16 v23, v214, v214
    v_dot2c_f32_bf16 v22, s67, v215
    v_dot2c_f32_bf16 v23, v215, v215
    v_dot2c_f32_bf16 v22, s67, v216
    v_dot2c_f32_bf16 v23, v216, v216
    v_dot2c_f32_bf16 v22, s67, v217
    v_dot2c_f32_bf16 v23, v217, v217
    v_dot2c_f32_bf16 v22, s67, v218
    v_dot2c_f32_bf16 v23, v218, v218
    v_dot2c_f32_bf16 v22, s67, v219
    v_dot2c_f32_bf16 v23, v219, v219
    v_dot2c_f32_bf16 v22, s67, v220
    v_dot2c_f32_bf16 v23, v220, v220
    v_dot2c_f32_bf16 v22, s67, v221
    v_dot2c_f32_bf16 v23, v221, v221
    v_dot2c_f32_bf16 v22, s67, v222
    v_dot2c_f32_bf16 v23, v222, v222
    v_dot2c_f32_bf16 v22, s67, v223
    v_dot2c_f32_bf16 v23, v223, v223
    s_waitcnt lgkmcnt(0)
    v_mfma_f32_32x32x16_bf16 v[112:127], v[224:227], v[56:59], v[112:127]
    s_add_u32 s61, s61, 13631488
    s_cmp_ge_u32 s62, 56
    s_cselect_b32 s31, 2, 0
    s_add_u32 s31, s31, s32
    s_lshl2_add_u32 s31, s0, s31
    v_mfma_f32_32x32x16_bf16 v[112:127], v[228:231], v[60:63], v[112:127]
    s_cmp_lt_u32 s62, 112
    s_cselect_b32 s61, s61, 1073741824
    s_cselect_b32 s31, s31, 28
    s_lshl_b32 s31, s31, 7
    s_lshl_b32 s40, s32, 5
    v_and_b32_e64 v1, 31, v0
    v_mfma_f32_32x32x16_bf16 v[112:127], v[232:235], v[64:67], v[112:127]
    v_add_u32 v1, s40, v1
    v_lshrrev_b32 v2, 1, v1
    v_sub_u32 v3, 64, v2
    v_cmp_eq_u32_e64 vcc, 1, v1
    s_nop 1
    v_cndmask_b32 v3, v3, 32, vcc
    v_and_b32 v28, 1, v1
    v_mfma_f32_32x32x16_bf16 v[112:127], v[236:239], v[68:71], v[112:127]
    s_waitcnt vmcnt(3)
    ds_read_b128 v[240:243], v128 offset:24576
    ds_read_b128 v[244:247], v129 offset:24576
    ds_read_b128 v[248:251], v130 offset:24576
    ds_read_b128 v[252:255], v131 offset:24576
    v_cmp_eq_u32 vcc, 1, v28
    s_nop 1
    v_cndmask_b32 v28, v2, v3, vcc
    v_cvt_f32_u32 v4, v28
    v_mul_f32 v4, 0x3c800000, v4
    v_dot2c_f32_bf16 v22, s67, v224
    v_dot2c_f32_bf16 v23, v224, v224
    v_dot2c_f32_bf16 v22, s67, v225
    v_dot2c_f32_bf16 v23, v225, v225
    v_dot2c_f32_bf16 v22, s67, v226
    v_dot2c_f32_bf16 v23, v226, v226
    v_dot2c_f32_bf16 v22, s67, v227
    v_dot2c_f32_bf16 v23, v227, v227
    v_dot2c_f32_bf16 v22, s67, v228
    v_dot2c_f32_bf16 v23, v228, v228
    v_dot2c_f32_bf16 v22, s67, v229
    v_dot2c_f32_bf16 v23, v229, v229
    v_dot2c_f32_bf16 v22, s67, v230
    v_dot2c_f32_bf16 v23, v230, v230
    v_dot2c_f32_bf16 v22, s67, v231
    v_dot2c_f32_bf16 v23, v231, v231
    v_dot2c_f32_bf16 v22, s67, v232
    v_dot2c_f32_bf16 v23, v232, v232
    v_dot2c_f32_bf16 v22, s67, v233
    v_dot2c_f32_bf16 v23, v233, v233
    v_dot2c_f32_bf16 v22, s67, v234
    v_dot2c_f32_bf16 v23, v234, v234
    v_dot2c_f32_bf16 v22, s67, v235
    v_dot2c_f32_bf16 v23, v235, v235
    v_dot2c_f32_bf16 v22, s67, v236
    v_dot2c_f32_bf16 v23, v236, v236
    v_dot2c_f32_bf16 v22, s67, v237
    v_dot2c_f32_bf16 v23, v237, v237
    v_dot2c_f32_bf16 v22, s67, v238
    v_dot2c_f32_bf16 v23, v238, v238
    v_dot2c_f32_bf16 v22, s67, v239
    v_dot2c_f32_bf16 v23, v239, v239
    s_waitcnt lgkmcnt(0)
    v_mfma_f32_32x32x16_bf16 v[112:127], v[240:243], v[72:75], v[112:127]
    v_lshrrev_b32 v2, 5, v0
    v_lshlrev_b32 v2, 1, v2
    v_lshlrev_b32 v7, 31, v28
    s_xor_b32 s40, s32, 0
    s_lshl_b32 s40, s40, 4
    v_add_u32 v3, s40, v2
    v_mfma_f32_32x32x16_bf16 v[112:127], v[244:247], v[76:79], v[112:127]
    v_cmp_eq_u32 vcc, 0, v3
    v_cvt_f32_u32 v3, v3
    v_fmaak_f32 v5, v3, v4, 0x3e000000
    v_cndmask_b32 v6, 0, v7, vcc
    v_fmamk_f32 v1, v4, 0x00000000, v5
    v_fmamk_f32 v8, v4, 0x3f800000, v5
    v_mfma_f32_32x32x16_bf16 v[112:127], v[248:251], v[80:83], v[112:127]
    v_cos_f32 v3, v1
    v_sin_f32 v1, v1
    v_cos_f32 v9, v8
    v_mfma_f32_32x32x16_bf16 v[112:127], v[252:255], v[84:87], v[112:127]
    v_sin_f32 v8, v8
    v_xor_b32_e64 v3, v3, v6
    v_cvt_pk_bf16_f32 v1, v1, v3
    v_cvt_pk_bf16_f32 v8, v8, v9
    v_accvgpr_write_b32 a224, v1
    v_accvgpr_write_b32 a225, v8
    v_fmamk_f32 v1, v4, 0x40800000, v5
    v_fmamk_f32 v8, v4, 0x40a00000, v5
    v_dot2c_f32_bf16 v22, s67, v240
    v_dot2c_f32_bf16 v23, v240, v240
    v_dot2c_f32_bf16 v22, s67, v241
    v_dot2c_f32_bf16 v23, v241, v241
    v_dot2c_f32_bf16 v22, s67, v242
    v_dot2c_f32_bf16 v23, v242, v242
    v_dot2c_f32_bf16 v22, s67, v243
    v_dot2c_f32_bf16 v23, v243, v243
    v_dot2c_f32_bf16 v22, s67, v244
    v_dot2c_f32_bf16 v23, v244, v244
    v_dot2c_f32_bf16 v22, s67, v245
    v_dot2c_f32_bf16 v23, v245, v245
    v_dot2c_f32_bf16 v22, s67, v246
    v_dot2c_f32_bf16 v23, v246, v246
    v_dot2c_f32_bf16 v22, s67, v247
    v_dot2c_f32_bf16 v23, v247, v247
    v_dot2c_f32_bf16 v22, s67, v248
    v_dot2c_f32_bf16 v23, v248, v248
    v_dot2c_f32_bf16 v22, s67, v249
    v_dot2c_f32_bf16 v23, v249, v249
    v_dot2c_f32_bf16 v22, s67, v250
    v_dot2c_f32_bf16 v23, v250, v250
    v_dot2c_f32_bf16 v22, s67, v251
    v_dot2c_f32_bf16 v23, v251, v251
    v_dot2c_f32_bf16 v22, s67, v252
    v_dot2c_f32_bf16 v23, v252, v252
    v_dot2c_f32_bf16 v22, s67, v253
    v_dot2c_f32_bf16 v23, v253, v253
    v_dot2c_f32_bf16 v22, s67, v254
    v_dot2c_f32_bf16 v23, v254, v254
    v_dot2c_f32_bf16 v22, s67, v255
    v_dot2c_f32_bf16 v23, v255, v255
    s_barrier
    s_nop 0
    v_mov_b32 v12, v22
    v_mov_b32 v13, v23
    s_mul_i32 s30, s36, 0x9e3779b1
    s_add_u32 s30, s30, 0x7f4a7c15
    s_lshr_b32 s30, s30, 2
    s_bitset1_b32 s30, 30
    v_permlane32_swap_b32 v22, v12
    v_add_f32 v12, v22, v12
    v_mul_f32 v12, 0xbb124925, v12
    v_cvt_pk_bf16_f32 v25, v12, v12
    v_accvgpr_write_b32 a192, v25
    v_lshlrev_b32 v128, 16, v25
    v_lshlrev_b32 v129, 16, v25
    v_pk_mov_b32 v[130:131], v[128:129], v[128:129]
    v_pk_mov_b32 v[132:133], v[128:129], v[128:129]
    v_pk_mov_b32 v[134:135], v[128:129], v[128:129]
    v_pk_mov_b32 v[136:137], v[128:129], v[128:129]
    v_pk_mov_b32 v[138:139], v[128:129], v[128:129]
    v_pk_mov_b32 v[140:141], v[128:129], v[128:129]
    v_pk_mov_b32 v[142:143], v[128:129], v[128:129]
    v_permlane32_swap_b32 v23, v13
    v_add_f32 v13, v23, v13
    v_mfma_f32_32x32x16_bf16 v[96:111], a[192:195], a[200:203], v[96:111]
    s_mov_b32 s66, 2000000
    s_mov_b32 s65, 0xbfb8aa3b
    s_mov_b32 s67, 1
    v_cmp_gt_u32 s[38:39], 32, v0
    v_cos_f32_e64 v3, v1
    s_mov_b64 s[68:69], 0
    s_load_dword s68, s[20:21], s42 offset:135040
    s_load_dword s69, s[20:21], 202624
    v_mfma_f32_32x32x16_bf16 v[64:79], a[240:243], v[144:147], v[128:143]
    v_mul_f32 v13, 0x3b124925, v13
    v_fma_f32 v13, -v12, v12, v13
    v_max_f32 v13, 0, v13
    v_cvt_pk_bf16_f32 v13, v13, v13
    v_lshlrev_b32 v13, 16, v13
    v_add_f32 v13, 0x3727c5ac, v13
    v_cvt_pk_bf16_f32 v13, v13, v13
    v_lshlrev_b32 v13, 16, v13
    v_mfma_f32_32x32x16_bf16 v[64:79], a[244:247], v[148:151], v[64:79]
    v_sqrt_f32 v13, v13
    v_fma_f32 v96, v112, v26, v96
    v_cvt_pk_bf16_f32 v13, v13, v13
    v_lshlrev_b32 v30, 16, v13
    v_rcp_f32 v13, v30
    v_fma_f32 v97, v113, v26, v97
    v_mul_f32_e64 v31, s65, v13
    v_mfma_f32_32x32x16_bf16 v[80:95], a[240:243], v[152:155], v[128:143]
    v_and_b32 v12, 0xffff0000, v13
    v_sub_f32_e64 v13, v13, v12
    v_cvt_pk_bf16_f32 v12, v12, v13
    v_cndmask_b32 v12, 0, v12, s[38:39]
    v_accvgpr_write_b32 a196, v12
    v_fma_f32 v98, v114, v26, v98
    v_fma_f32 v99, v115, v26, v99
    v_fma_f32 v100, v116, v26, v100
    v_fma_f32 v101, v117, v26, v101
    v_mfma_f32_32x32x16_bf16 v[80:95], a[244:247], v[156:159], v[80:95]
    v_cvt_pk_bf16_f32 v144, v64, v65
    v_cvt_pk_bf16_f32 v145, v66, v67
    v_cvt_pk_bf16_f32 v146, v68, v69
    v_cvt_pk_bf16_f32 v147, v70, v71
    v_cvt_pk_bf16_f32 v148, v72, v73
    v_cvt_pk_bf16_f32 v149, v74, v75
    v_cvt_pk_bf16_f32 v150, v76, v77
    v_cvt_pk_bf16_f32 v151, v78, v79
    v_fma_f32 v102, v118, v26, v102
    v_mfma_f32_32x32x16_bf16 v[64:79], a[240:243], v[160:163], v[128:143]
    v_fma_f32 v103, v119, v26, v103
    v_fma_f32 v104, v120, v26, v104
    v_fma_f32 v105, v121, v26, v105
    v_fma_f32 v106, v122, v26, v106
    v_fma_f32 v107, v123, v26, v107
    v_fma_f32 v108, v124, v26, v108
    v_fma_f32 v109, v125, v26, v109
    v_fma_f32 v110, v126, v26, v110
    v_fma_f32 v111, v127, v26, v111
    v_mfma_f32_32x32x16_bf16 v[112:127], a[196:199], a[252:255], 0
    v_sin_f32 v1, v1
    v_cos_f32 v9, v8
    v_sin_f32_e64 v8, v8
    v_mfma_f32_32x32x16_bf16 v[64:79], a[244:247], v[164:167], v[64:79]
    v_cvt_pk_bf16_f32 v152, v80, v81
    v_cvt_pk_bf16_f32 v153, v82, v83
    v_cvt_pk_bf16_f32 v154, v84, v85
    v_cvt_pk_bf16_f32 v155, v86, v87
    v_cvt_pk_bf16_f32 v156, v88, v89
    v_cvt_pk_bf16_f32 v157, v90, v91
    v_cvt_pk_bf16_f32 v158, v92, v93
    v_cvt_pk_bf16_f32 v159, v94, v95
    v_mfma_f32_32x32x16_bf16 v[80:95], a[240:243], v[168:171], v[128:143]
    v_mul_f32 v96, v96, v112
    v_mul_f32 v97, v97, v113
    v_mul_f32 v98, v98, v114
    v_mul_f32 v99, v99, v115
    v_mul_f32 v100, v100, v116
    v_mul_f32 v101, v101, v117
    v_mul_f32 v102, v102, v118
    v_mul_f32 v103, v103, v119
    v_cvt_pk_bf16_f32 v112, v96, v97
    v_mfma_f32_32x32x16_bf16 v[80:95], a[244:247], v[172:175], v[80:95]
    v_cvt_pk_bf16_f32 v160, v64, v65
    v_cvt_pk_bf16_f32 v161, v66, v67
    v_cvt_pk_bf16_f32 v162, v68, v69
    v_cvt_pk_bf16_f32 v163, v70, v71
    v_cvt_pk_bf16_f32 v164, v72, v73
    v_cvt_pk_bf16_f32 v165, v74, v75
    v_cvt_pk_bf16_f32 v166, v76, v77
    v_cvt_pk_bf16_f32 v167, v78, v79
    v_cvt_pk_bf16_f32 v113, v98, v99
    v_mfma_f32_32x32x16_bf16 v[64:79], a[240:243], v[176:179], v[128:143]
    v_cvt_pk_bf16_f32 v114, v100, v101
    v_cvt_pk_bf16_f32 v115, v102, v103
    v_mul_f32 v104, v104, v120
    v_mul_f32 v105, v105, v121
    v_mul_f32 v106, v106, v122
    v_mul_f32 v107, v107, v123
    v_mul_f32 v108, v108, v124
    v_mul_f32 v109, v109, v125
    v_mul_f32_e64 v110, v110, v126
    v_mfma_f32_32x32x16_bf16 v[64:79], a[244:247], v[180:183], v[64:79]
    v_cvt_pk_bf16_f32 v168, v80, v81
    v_cvt_pk_bf16_f32 v169, v82, v83
    v_cvt_pk_bf16_f32 v170, v84, v85
    v_cvt_pk_bf16_f32 v171, v86, v87
    v_cvt_pk_bf16_f32 v172, v88, v89
    v_cvt_pk_bf16_f32 v173, v90, v91
    v_cvt_pk_bf16_f32 v174, v92, v93
    v_cvt_pk_bf16_f32 v175, v94, v95
    v_mul_f32_e64 v111, v111, v127
    v_mfma_f32_32x32x16_bf16 v[80:95], a[240:243], v[184:187], v[128:143]
    v_cvt_pk_bf16_f32 v116, v104, v105
    v_cvt_pk_bf16_f32 v117, v106, v107
    v_cvt_pk_bf16_f32 v118, v108, v109
    v_cvt_pk_bf16_f32 v119, v110, v111
    v_cvt_pk_bf16_f32 v1, v1, v3
    v_cvt_pk_bf16_f32 v8, v8, v9
    v_xor_b32 v10, 64, v29
    ds_write_b128 v20, v[112:115] offset:0
    ds_write_b128 v20, v[116:119] offset:1024
    s_waitcnt vmcnt(1)
    ds_read_b64_tr_b16 a[212:213], v29 offset:0
    ds_read_b64_tr_b16 a[214:215], v29 offset:1024
    ds_read_b64_tr_b16 a[216:217], v10 offset:0
    ds_read_b64_tr_b16 a[218:219], v10 offset:1024
    s_add_u32 m0, s34, 0
    s_lshl1_add_u32 s35, s53, 0
    buffer_load_dwordx4 v14, s[8:11], s35 offen offset:0  lds
    v_mfma_f32_32x32x16_bf16 v[80:95], a[244:247], v[188:191], v[80:95]
    v_cvt_pk_bf16_f32 v176, v64, v65
    v_cvt_pk_bf16_f32 v177, v66, v67
    v_cvt_pk_bf16_f32 v178, v68, v69
    v_cvt_pk_bf16_f32 v179, v70, v71
    v_cvt_pk_bf16_f32 v180, v72, v73
    v_cvt_pk_bf16_f32 v181, v74, v75
    v_cvt_pk_bf16_f32 v182, v76, v77
    v_cvt_pk_bf16_f32 v183, v78, v79
    v_mfma_f32_32x32x16_bf16 v[64:79], a[240:243], v[192:195], v[128:143]
    v_accvgpr_write_b32 a226, v1
    v_accvgpr_write_b32 a227, v8
    v_fmamk_f32 v1, v4, 0x41000000, v5
    v_fmamk_f32 v8, v4, 0x41100000, v5
    v_cos_f32_e64 v3, v1
    v_mfma_f32_32x32x16_bf16 v[64:79], a[244:247], v[196:199], v[64:79]
    buffer_load_dwordx4 v15, s[8:11], s35 offen offset:1024  lds
    v_cvt_pk_bf16_f32 v184, v80, v81
    v_cvt_pk_bf16_f32 v185, v82, v83
    v_cvt_pk_bf16_f32 v186, v84, v85
    v_cvt_pk_bf16_f32 v187, v86, v87
    v_cvt_pk_bf16_f32 v188, v88, v89
    v_cvt_pk_bf16_f32 v189, v90, v91
    v_cvt_pk_bf16_f32 v190, v92, v93
    v_cvt_pk_bf16_f32 v191, v94, v95
    s_waitcnt lgkmcnt(4)
    s_barrier
    ds_read_b128 a[204:207], v21 offset:0
    ds_read_b128 a[208:211], v21 offset:1024
    s_waitcnt lgkmcnt(4)
    buffer_store_dwordx4 a[212:215], v24, s[20:23], s61 offen sc1
    s_add_u32 s61, s61, 114688
    s_waitcnt lgkmcnt(2)
    buffer_store_dwordx4 a[216:219], v24, s[20:23], s61 offen sc1
    v_mfma_f32_32x32x16_bf16 v[80:95], a[240:243], v[200:203], v[128:143]
    buffer_load_dwordx4 v16, s[12:15], s35 offen offset:2048  lds
    v_sin_f32 v1, v1
    v_cos_f32 v9, v8
    v_mfma_f32_32x32x16_bf16 v[80:95], a[244:247], v[204:207], v[80:95]
    v_cvt_pk_bf16_f32 v192, v64, v65
    v_cvt_pk_bf16_f32 v193, v66, v67
    v_cvt_pk_bf16_f32 v194, v68, v69
    v_cvt_pk_bf16_f32 v195, v70, v71
    v_cvt_pk_bf16_f32 v196, v72, v73
    v_cvt_pk_bf16_f32 v197, v74, v75
    v_cvt_pk_bf16_f32 v198, v76, v77
    v_cvt_pk_bf16_f32 v199, v78, v79
    s_sub_u32 s44, s68, s30
    s_cmp_eq_u32 s44, 1
    s_cbranch_scc0 L_slow0
    s_sub_u32 s44, s69, s30
    s_cmp_eq_u32 s44, 1
    s_cbranch_scc0 L_slow0
L_ok0:
    v_mfma_f32_32x32x16_bf16 v[64:79], a[240:243], v[208:211], v[128:143]
    buffer_load_dwordx4 v17, s[12:15], s35 offen offset:3072  lds
    v_sin_f32_e64 v8, v8
    v_cvt_pk_bf16_f32 v1, v1, v3
    v_cvt_pk_bf16_f32 v8, v8, v9
    v_accvgpr_write_b32 a228, v1
    v_mfma_f32_32x32x16_bf16 v[64:79], a[244:247], v[212:215], v[64:79]
    v_cvt_pk_bf16_f32 v200, v80, v81
    v_cvt_pk_bf16_f32 v201, v82, v83
    v_cvt_pk_bf16_f32 v202, v84, v85
    v_cvt_pk_bf16_f32 v203, v86, v87
    v_cvt_pk_bf16_f32 v204, v88, v89
    v_cvt_pk_bf16_f32 v205, v90, v91
    v_cvt_pk_bf16_f32 v206, v92, v93
    v_cvt_pk_bf16_f32 v207, v94, v95
    v_mfma_f32_32x32x16_bf16 v[80:95], a[240:243], v[216:219], v[128:143]
    s_add_u32 m0, s34, 16384
    s_lshl1_add_u32 s35, s54, 0
    buffer_load_dwordx4 v14, s[8:11], s35 offen offset:0  lds
    s_nop 0
    v_accvgpr_write_b32 a229, v8
    v_fmamk_f32 v1, v4, 0x41400000, v5
    v_fmamk_f32 v8, v4, 0x41500000, v5
    v_mfma_f32_32x32x16_bf16 v[80:95], a[244:247], v[220:223], v[80:95]
    v_cvt_pk_bf16_f32 v208, v64, v65
    v_cvt_pk_bf16_f32 v209, v66, v67
    v_cvt_pk_bf16_f32 v210, v68, v69
    v_cvt_pk_bf16_f32 v211, v70, v71
    v_cvt_pk_bf16_f32 v212, v72, v73
    v_cvt_pk_bf16_f32 v213, v74, v75
    v_cvt_pk_bf16_f32 v214, v76, v77
    v_cvt_pk_bf16_f32 v215, v78, v79
    v_cos_f32 v3, v1
    v_sin_f32 v1, v1
    v_cos_f32 v9, v8
    v_sin_f32 v8, v8
    buffer_load_dwordx4 v15, s[8:11], s35 offen offset:1024  lds
    v_cvt_pk_bf16_f32 v1, v1, v3
    v_cvt_pk_bf16_f32 v8, v8, v9
    v_accvgpr_write_b32 a230, v1
    v_accvgpr_write_b32 a231, v8
    s_xor_b32 s40, s32, 1
    s_lshl_b32 s40, s40, 4
    v_add_u32 v3, s40, v2
    v_cmp_eq_u32 vcc, 0, v3
    v_cvt_f32_u32 v3, v3
    v_fmaak_f32 v5, v3, v4, 0x3e000000
    v_cndmask_b32 v6, 0, v7, vcc
    v_fmamk_f32 v1, v4, 0x00000000, v5
    v_fmamk_f32 v8, v4, 0x3f800000, v5
    v_cos_f32 v3, v1
    v_sin_f32 v1, v1
    v_cos_f32 v9, v8
    buffer_load_dwordx4 v16, s[12:15], s35 offen offset:2048  lds
    v_sin_f32 v8, v8
    v_xor_b32_e64 v3, v3, v6
    v_cvt_pk_bf16_f32 v1, v1, v3
    v_cvt_pk_bf16_f32 v8, v8, v9
    v_accvgpr_write_b32 a232, v1
    v_accvgpr_write_b32 a233, v8
    v_fmamk_f32 v1, v4, 0x40800000, v5
    v_fmamk_f32 v8, v4, 0x40a00000, v5
    v_cos_f32 v3, v1
    v_sin_f32 v1, v1
    v_cos_f32 v9, v8
    v_sin_f32 v8, v8
    v_cvt_pk_bf16_f32 v1, v1, v3
    v_cvt_pk_bf16_f32 v8, v8, v9
    v_accvgpr_write_b32 a234, v1
    v_accvgpr_write_b32 a235, v8
    buffer_load_dwordx4 v17, s[12:15], s35 offen offset:3072  lds
    v_fmamk_f32 v1, v4, 0x41000000, v5
    v_fmamk_f32 v8, v4, 0x41100000, v5
    v_cos_f32 v3, v1
    v_sin_f32 v1, v1
    v_cos_f32 v9, v8
    v_sin_f32 v8, v8
    v_cvt_pk_bf16_f32 v1, v1, v3
    v_cvt_pk_bf16_f32 v8, v8, v9
    v_accvgpr_write_b32 a236, v1
    v_accvgpr_write_b32 a237, v8
    v_fmamk_f32 v1, v4, 0x41400000, v5
    v_fmamk_f32 v8, v4, 0x41500000, v5
    v_cos_f32 v3, v1
    v_sin_f32 v1, v1
    v_cos_f32 v9, v8
    v_sin_f32_e64 v8, v8
    s_add_u32 m0, s34, 32768
    s_lshl1_add_u32 s35, s55, 0
    buffer_load_dwordx4 v14, s[8:11], s35 offen offset:0  lds
    v_cvt_pk_bf16_f32 v1, v1, v3
    v_cvt_pk_bf16_f32 v8, v8, v9
    v_accvgpr_write_b32 a238, v1
    v_accvgpr_write_b32 a239, v8
    v_mfma_f32_32x32x16_bf16 v[96:111], a[224:227], v[112:115], 0
    v_lshrrev_b32 v4, 5, v0
    v_mul_u32_u24 v7, 114688, v4
    v_and_b32 v3, 31, v0
    v_lshl_add_u32 v7, v3, 2, v7
    s_mul_i32 s63, s32, 917504
    s_lshl_b32 s40, s29, 12
    v_mfma_f32_32x32x16_bf16 v[96:111], a[228:231], v[116:119], v[96:111]
    buffer_load_dwordx4 v15, s[8:11], s35 offen offset:1024  lds
    s_add_u32 s63, s63, s40
    s_lshl1_add_u32 s40, s28, s33
    s_lshl_b32 s40, s40, 7
    s_add_u32 s63, s63, s40
    s_add_u32 s63, s63, 1048576
    s_waitcnt lgkmcnt(1)
    v_mfma_f32_32x32x16_bf16 v[96:111], a[232:235], a[204:207], v[96:111]
    s_lshl_b32 s64, s3, 7
    s_add_u32 s64, s64, s42
    v_bfe_u32 v3, v0, 4, 1
    v_bfe_u32 v5, v0, 2, 2
    v_and_b32 v6, 3, v0
    v_lshl_add_u32 v1, v3, 1, v4
    s_waitcnt lgkmcnt(0)
    v_mfma_f32_32x32x16_bf16 v[96:111], a[236:239], a[208:211], v[96:111]
    buffer_load_dwordx4 v16, s[12:15], s35 offen offset:2048  lds
    v_lshlrev_b32 v1, 10, v1
    v_lshl_add_u32 v1, v5, 7, v1
    v_lshl_add_u32 v1, v6, 3, v1
    v_and_b32 v2, 2, v5
    v_add_u32_e64 v2, v2, v3
    v_mfma_f32_32x32x16_bf16 v[64:79], a[240:243], v[224:227], v[128:143]
    v_lshl_add_u32 v18, v2, 5, v1
    v_add_u32 v19, 0x10000, v18
    v_add_u32 v20, 0x20000, v18
    v_xor_b32 v21, 32, v18
    v_xor_b32 v22, 32, v19
    v_xor_b32_e64 v23, 32, v20
    v_mfma_f32_32x32x16_bf16 v[64:79], a[244:247], v[228:231], v[64:79]
    buffer_load_dwordx4 v17, s[12:15], s35 offen offset:3072  lds
    v_cvt_pk_bf16_f32 v216, v80, v81
    v_cvt_pk_bf16_f32 v217, v82, v83
    v_cvt_pk_bf16_f32 v218, v84, v85
    v_cvt_pk_bf16_f32 v219, v86, v87
    v_cvt_pk_bf16_f32 v220, v88, v89
    v_cvt_pk_bf16_f32 v221, v90, v91
    v_cvt_pk_bf16_f32 v222, v92, v93
    v_cvt_pk_bf16_f32 v223, v94, v95
    v_mfma_f32_32x32x16_bf16 v[80:95], a[240:243], v[232:235], v[128:143]
    v_cvt_pk_bf16_f32 v120, v96, v97
    v_cvt_pk_bf16_f32 v121, v98, v99
    v_cvt_pk_bf16_f32 v122, v100, v101
    v_cvt_pk_bf16_f32 v123, v102, v103
    v_cvt_pk_bf16_f32 v124, v104, v105
    v_cvt_pk_bf16_f32 v125, v106, v107
    v_cvt_pk_bf16_f32 v126, v108, v109
    v_cvt_pk_bf16_f32 v127, v110, v111
    v_mfma_f32_32x32x16_bf16 v[80:95], a[244:247], v[236:239], v[80:95]
    s_add_u32 m0, s34, 65536
    s_lshl1_add_u32 s35, s56, 0
    s_nop 0
    buffer_load_dwordx4 v14, s[8:11], s35 offen offset:0  lds
    v_cvt_pk_bf16_f32 v224, v64, v65
    v_cvt_pk_bf16_f32 v225, v66, v67
    v_cvt_pk_bf16_f32 v226, v68, v69
    v_cvt_pk_bf16_f32 v227, v70, v71
    v_cvt_pk_bf16_f32 v228, v72, v73
    v_cvt_pk_bf16_f32 v229, v74, v75
    v_cvt_pk_bf16_f32 v230, v76, v77
    v_cvt_pk_bf16_f32 v231, v78, v79
    v_mfma_f32_32x32x16_bf16 v[64:79], a[240:243], v[240:243], v[128:143]
    s_add_u32 s37, s63, 0
    buffer_store_dword v120, v7, s[20:23], s37 offen sc1
    s_nop 0
    s_add_u32 s37, s63, 57344
    buffer_store_dword v121, v7, s[20:23], s37 offen sc1
    s_add_u32 s37, s63, 229376
    buffer_store_dword v122, v7, s[20:23], s37 offen sc1
    s_add_u32 s37, s63, 286720
    buffer_store_dword v123, v7, s[20:23], s37 offen sc1
    s_waitcnt vmcnt(15)
    s_atomic_add s67, s[20:21], s31 offset:198656
    s_nop 0
    v_mfma_f32_32x32x16_bf16 v[64:79], a[244:247], v[244:247], v[64:79]
    buffer_load_dwordx4 v15, s[8:11], s35 offen offset:1024  lds
    v_cvt_pk_bf16_f32 v232, v80, v81
    v_cvt_pk_bf16_f32 v233, v82, v83
L_padg1:
    s_cbranch_execz L_padg5
    v_cvt_pk_bf16_f32 v234, v84, v85
    v_cvt_pk_bf16_f32 v235, v86, v87
    v_cvt_pk_bf16_f32 v236, v88, v89
    s_nop 0
    v_cvt_pk_bf16_f32 v237, v90, v91
    v_cvt_pk_bf16_f32 v238, v92, v93
    v_cvt_pk_bf16_f32 v239, v94, v95
    v_mfma_f32_32x32x16_bf16 v[80:95], a[240:243], v[248:251], v[128:143]
    s_waitcnt vmcnt(14)
    s_barrier
    ds_read_b64_tr_b16 v[32:33], v18 offset:0
    ds_read_b64_tr_b16 v[34:35], v18 offset:512
    ds_read_b64_tr_b16 v[36:37], v21 offset:0
    ds_read_b64_tr_b16 v[38:39], v21 offset:512
    s_add_u32 s37, s63, 458752
    buffer_store_dword v124, v7, s[20:23], s37 offen sc1
    v_mfma_f32_32x32x16_bf16 v[80:95], a[244:247], v[252:255], v[80:95]
    buffer_load_dwordx4 v16, s[12:15], s35 offen offset:2048  lds
    ds_read_b64_tr_b16 v[40:41], v18 offset:4096
    ds_read_b64_tr_b16 v[42:43], v18 offset:4608
    ds_read_b64_tr_b16 v[44:45], v21 offset:4096
    ds_read_b64_tr_b16 v[46:47], v21 offset:4608
    v_cvt_pk_bf16_f32 v240, v64, v65
    v_cvt_pk_bf16_f32 v241, v66, v67
    v_cvt_pk_bf16_f32 v242, v68, v69
    v_cvt_pk_bf16_f32 v243, v70, v71
    v_cvt_pk_bf16_f32 v244, v72, v73
    v_cvt_pk_bf16_f32 v245, v74, v75
    v_cvt_pk_bf16_f32 v246, v76, v77
    v_cvt_pk_bf16_f32 v247, v78, v79
    ds_read_b64_tr_b16 v[48:49], v18 offset:8192
    ds_read_b64_tr_b16 v[50:51], v18 offset:8704
    ds_read_b64_tr_b16 v[52:53], v21 offset:8192
    ds_read_b64_tr_b16 v[54:55], v21 offset:8704
    v_cvt_pk_bf16_f32 v248, v80, v81
    v_cvt_pk_bf16_f32 v249, v82, v83
    v_cvt_pk_bf16_f32 v250, v84, v85
    v_cvt_pk_bf16_f32 v251, v86, v87
    v_cvt_pk_bf16_f32 v252, v88, v89
    v_cvt_pk_bf16_f32 v253, v90, v91
    v_cvt_pk_bf16_f32 v254, v92, v93
    v_cvt_pk_bf16_f32 v255, v94, v95
    s_waitcnt lgkmcnt(4)
    v_mfma_f32_32x32x16_bf16 v[64:79], v[32:35], v[144:147], 0
    ds_read_b64_tr_b16 v[56:57], v18 offset:12288
    s_nop 0
    ds_read_b64_tr_b16 v[58:59], v18 offset:12800
    s_add_u32 s37, s63, 516096
    buffer_store_dword v125, v7, s[20:23], s37 offen sc1
    s_add_u32 s37, s63, 688128
    buffer_store_dword v126, v7, s[20:23], s37 offen sc1
    v_mfma_f32_32x32x16_bf16 v[80:95], v[36:39], v[144:147], 0
    ds_read_b64_tr_b16 v[60:61], v21 offset:12288
    ds_read_b64_tr_b16 v[62:63], v21 offset:12800
    buffer_load_dwordx4 v17, s[12:15], s35 offen offset:3072  lds
    s_add_u32 s37, s63, 745472
    buffer_store_dword v127, v7, s[20:23], s37 offen sc1
    v_mfma_f32_32x32x16_bf16 v[64:79], v[40:43], v[148:151], v[64:79]
    s_waitcnt vmcnt(16)
    s_barrier
    ds_read_b64_tr_b16 v[32:33], v18 offset:16384
    ds_read_b64_tr_b16 v[34:35], v18 offset:16896
    s_mul_i32 s38, s32, 14336
    s_lshl_b32 s39, s33, 10
    v_mfma_f32_32x32x16_bf16 v[80:95], v[44:47], v[148:151], v[80:95]
    ds_read_b64_tr_b16 v[36:37], v21 offset:16384
    ds_read_b64_tr_b16 v[38:39], v21 offset:16896
    s_nop 0
    s_add_u32 m0, s34, 81920
    s_lshl1_add_u32 s35, s57, 0
    buffer_load_dwordx4 v14, s[8:11], s35 offen offset:0  lds
    s_waitcnt lgkmcnt(4)
    v_mfma_f32_32x32x16_bf16 v[64:79], v[48:51], v[152:155], v[64:79]
    ds_read_b64_tr_b16 v[40:41], v18 offset:20480
    ds_read_b64_tr_b16 v[42:43], v18 offset:20992
    s_add_u32 s38, s38, s39
    v_add_u32 v29, s38, v24
    s_lshl1_add_u32 s38, s0, s33
    s_xor_b32 s39, s38, 1
    v_mfma_f32_32x32x16_bf16 v[80:95], v[52:55], v[152:155], v[80:95]
    ds_read_b64_tr_b16 v[44:45], v21 offset:20480
    ds_read_b64_tr_b16 v[46:47], v21 offset:20992
    buffer_load_dwordx4 v15, s[8:11], s35 offen offset:1024  lds
    s_mul_i32 s38, s38, 114688
    s_mul_i32 s39, s39, 114688
    s_add_u32 s38, s38, 13631488
    v_mfma_f32_32x32x16_bf16 v[64:79], v[56:59], v[156:159], v[64:79]
    ds_read_b64_tr_b16 v[48:49], v18 offset:24576
    ds_read_b64_tr_b16 v[50:51], v18 offset:25088
    s_add_u32 s39, s39, 13631488
    v_add_u32 v10, s38, v29
    v_add_u32 v11, s39, v29
    s_lshl1_add_u32 s16, s32, s33
    v_mfma_f32_32x32x16_bf16 v[80:95], v[60:63], v[156:159], v[80:95]
    ds_read_b64_tr_b16 v[52:53], v21 offset:24576
    ds_read_b64_tr_b16 v[54:55], v21 offset:25088
    buffer_load_dwordx4 v16, s[12:15], s35 offen offset:2048  lds
    s_lshl2_add_u32 s36, s0, s16
    s_lshl_b32 s36, s36, 7
    s_waitcnt lgkmcnt(4)
    v_mfma_f32_32x32x16_bf16 v[64:79], v[32:35], v[160:163], v[64:79]
    ds_read_b64_tr_b16 v[56:57], v18 offset:28672
    ds_read_b64_tr_b16 v[58:59], v18 offset:29184
    s_lshl1_add_u32 s61, s33, s45
    s_lshl_b32 s61, s61, 7
    s_add_u32 s61, s61, s42
    s_lshl1_add_u32 s62, s45, s32
    v_mfma_f32_32x32x16_bf16 v[80:95], v[36:39], v[160:163], v[80:95]
    ds_read_b64_tr_b16 v[60:61], v21 offset:28672
    ds_read_b64_tr_b16 v[62:63], v21 offset:29184
    buffer_load_dwordx4 v17, s[12:15], s35 offen offset:3072  lds
    s_lshl_b32 s62, s62, 7
    s_add_u32 s62, s62, s42
    s_lshl_b32 s18, s32, 7
    v_mfma_f32_32x32x16_bf16 v[64:79], v[40:43], v[164:167], v[64:79]
    s_waitcnt vmcnt(16)
    s_barrier
    ds_read_b64_tr_b16 v[32:33], v18 offset:32768
    ds_read_b64_tr_b16 v[34:35], v18 offset:33280
    s_add_u32 s18, s18, s42
    s_mov_b32 s26, 1835008
    v_mfma_f32_32x32x16_bf16 v[80:95], v[44:47], v[164:167], v[80:95]
    ds_read_b64_tr_b16 v[36:37], v21 offset:32768
    ds_read_b64_tr_b16 v[38:39], v21 offset:33280
    s_add_u32 m0, s34, 98304
    s_lshl1_add_u32 s35, s58, 0
    buffer_load_dwordx4 v14, s[8:11], s35 offen offset:0  lds
    s_waitcnt lgkmcnt(4)
    v_mfma_f32_32x32x16_bf16 v[64:79], v[48:51], v[168:171], v[64:79]
    ds_read_b64_tr_b16 v[40:41], v18 offset:36864
    ds_read_b64_tr_b16 v[42:43], v18 offset:37376
    s_mov_b32 s27, 0x00020000
    s_lshl2_add_u32 s38, s28, s3
    s_mul_i32 s60, s38, 114688
    s_lshl_b32 s39, s29, 11
    v_mfma_f32_32x32x16_bf16 v[80:95], v[52:55], v[168:171], v[80:95]
    ds_read_b64_tr_b16 v[44:45], v21 offset:36864
    ds_read_b64_tr_b16 v[46:47], v21 offset:37376
    buffer_load_dwordx4 v15, s[8:11], s35 offen offset:1024  lds
    s_add_u32 s60, s60, s39
    s_add_u32 s60, s60, 5242880
    s_lshl1_add_u32 s38, s1, s32
    v_mfma_f32_32x32x16_bf16 v[64:79], v[56:59], v[172:175], v[64:79]
    ds_read_b64_tr_b16 v[48:49], v18 offset:40960
    ds_read_b64_tr_b16 v[50:51], v18 offset:41472
    s_xor_b32 s39, s38, 1
    s_nop 0
    s_mul_i32 s38, s38, 114688
    s_mul_i32 s39, s39, 114688
    s_add_u32 s38, s38, 5242880
    v_mfma_f32_32x32x16_bf16 v[80:95], v[60:63], v[172:175], v[80:95]
    ds_read_b64_tr_b16 v[52:53], v21 offset:40960
    ds_read_b64_tr_b16 v[54:55], v21 offset:41472
    buffer_load_dwordx4 v16, s[12:15], s35 offen offset:2048  lds
    s_add_u32 s39, s39, 5242880
    v_add_u32_e64 v12, s38, v29
    s_waitcnt lgkmcnt(4)
    v_mfma_f32_32x32x16_bf16 v[64:79], v[32:35], v[176:179], v[64:79]
    s_mov_b32 s69, 0
    s_atomic_add s69, s[20:21], s36 offset:198656 glc
    ds_read_b64_tr_b16 v[56:57], v18 offset:45056
    ds_read_b64_tr_b16 v[58:59], v18 offset:45568
    v_add_u32 v13, s39, v29
    s_lshl_b32 s17, s16, 14
    v_mfma_f32_32x32x16_bf16 v[80:95], v[36:39], v[176:179], v[80:95]
    ds_read_b64_tr_b16 v[60:61], v21 offset:45056
    ds_read_b64_tr_b16 v[62:63], v21 offset:45568
    buffer_load_dwordx4 v17, s[12:15], s35 offen offset:3072  lds
    s_add_u32 s17, s17, 81920
    s_lshl2_add_u32 s16, s1, s16
    s_mul_i32 s16, s16, 14336
    v_mfma_f32_32x32x16_bf16 v[64:79], v[40:43], v[180:183], v[64:79]
    s_waitcnt vmcnt(9)
    s_barrier
    s_nop 0
    ds_read_b64_tr_b16 v[32:33], v19 offset:0
    ds_read_b64_tr_b16 v[34:35], v19 offset:512
    s_add_u32 s16, s16, 3145728
    v_mfma_f32_32x32x16_bf16 v[80:95], v[44:47], v[180:183], v[80:95]
    ds_read_b64_tr_b16 v[36:37], v22 offset:0
    ds_read_b64_tr_b16 v[38:39], v22 offset:512
    s_add_u32 m0, s34, 114688
    s_lshl1_add_u32 s35, s59, 0
    buffer_load_dwordx4 v14, s[8:11], s35 offen offset:0  lds
    s_waitcnt lgkmcnt(4)
    v_mfma_f32_32x32x16_bf16 v[64:79], v[48:51], v[184:187], v[64:79]
    ds_read_b64_tr_b16 v[40:41], v19 offset:4096
    ds_read_b64_tr_b16 v[42:43], v19 offset:4608
    v_mfma_f32_32x32x16_bf16 v[80:95], v[52:55], v[184:187], v[80:95]
    ds_read_b64_tr_b16 v[44:45], v22 offset:4096
    ds_read_b64_tr_b16 v[46:47], v22 offset:4608
    buffer_load_dwordx4 v15, s[8:11], s35 offen offset:1024  lds
    s_waitcnt vmcnt(10)
    s_atomic_add s67, s[20:21], s64 offset:133120
    v_mfma_f32_32x32x16_bf16 v[64:79], v[56:59], v[188:191], v[64:79]
    ds_read_b64_tr_b16 v[48:49], v19 offset:8192
    s_nop 0
    ds_read_b64_tr_b16 v[50:51], v19 offset:8704
    v_mfma_f32_32x32x16_bf16 v[80:95], v[60:63], v[188:191], v[80:95]
    ds_read_b64_tr_b16 v[52:53], v22 offset:8192
    ds_read_b64_tr_b16 v[54:55], v22 offset:8704
    buffer_load_dwordx4 v16, s[12:15], s35 offen offset:2048  lds
    s_waitcnt lgkmcnt(4)
    v_mfma_f32_32x32x16_bf16 v[64:79], v[32:35], v[192:195], v[64:79]
    ds_read_b64_tr_b16 v[56:57], v19 offset:12288
    s_nop 0
    ds_read_b64_tr_b16 v[58:59], v19 offset:12800
    v_mfma_f32_32x32x16_bf16 v[80:95], v[36:39], v[192:195], v[80:95]
    ds_read_b64_tr_b16 v[60:61], v22 offset:12288
    ds_read_b64_tr_b16 v[62:63], v22 offset:12800
    buffer_load_dwordx4 v17, s[12:15], s35 offen offset:3072  lds
    v_mfma_f32_32x32x16_bf16 v[64:79], v[40:43], v[196:199], v[64:79]
    s_waitcnt vmcnt(8)
    s_barrier
    ds_read_b64_tr_b16 v[32:33], v19 offset:16384
    ds_read_b64_tr_b16 v[34:35], v19 offset:16896
    v_mfma_f32_32x32x16_bf16 v[80:95], v[44:47], v[196:199], v[80:95]
    ds_read_b64_tr_b16 v[36:37], v22 offset:16384
    ds_read_b64_tr_b16 v[38:39], v22 offset:16896
    s_add_u32 m0, s34, 131072
    s_lshl1_add_u32 s35, s53, 128
    buffer_load_dwordx4 v14, s[8:11], s35 offen offset:0  lds
    s_waitcnt lgkmcnt(4)
    s_nop 0
    v_mfma_f32_32x32x16_bf16 v[64:79], v[48:51], v[200:203], v[64:79]
    ds_read_b64_tr_b16 v[40:41], v19 offset:20480
    ds_read_b64_tr_b16 v[42:43], v19 offset:20992
    v_mfma_f32_32x32x16_bf16 v[80:95], v[52:55], v[200:203], v[80:95]
    ds_read_b64_tr_b16 v[44:45], v22 offset:20480
    ds_read_b64_tr_b16 v[46:47], v22 offset:20992
    buffer_load_dwordx4 v15, s[8:11], s35 offen offset:1024  lds
    v_mfma_f32_32x32x16_bf16 v[64:79], v[56:59], v[204:207], v[64:79]
    ds_read_b64_tr_b16 v[48:49], v19 offset:24576
    ds_read_b64_tr_b16 v[50:51], v19 offset:25088
    v_mfma_f32_32x32x16_bf16 v[80:95], v[60:63], v[204:207], v[80:95]
    ds_read_b64_tr_b16 v[52:53], v22 offset:24576
    ds_read_b64_tr_b16 v[54:55], v22 offset:25088
    buffer_load_dwordx4 v16, s[12:15], s35 offen offset:2048  lds
    s_waitcnt lgkmcnt(4)
    v_mfma_f32_32x32x16_bf16 v[64:79], v[32:35], v[208:211], v[64:79]
    s_nop 0
    ds_read_b64_tr_b16 v[56:57], v19 offset:28672
    ds_read_b64_tr_b16 v[58:59], v19 offset:29184
    v_mfma_f32_32x32x16_bf16 v[80:95], v[36:39], v[208:211], v[80:95]
    ds_read_b64_tr_b16 v[60:61], v22 offset:28672
    ds_read_b64_tr_b16 v[62:63], v22 offset:29184
    buffer_load_dwordx4 v17, s[12:15], s35 offen offset:3072  lds
    v_mfma_f32_32x32x16_bf16 v[64:79], v[40:43], v[212:215], v[64:79]
    s_waitcnt vmcnt(8)
    s_barrier
    ds_read_b64_tr_b16 v[32:33], v19 offset:32768
    ds_read_b64_tr_b16 v[34:35], v19 offset:33280
    v_mfma_f32_32x32x16_bf16 v[80:95], v[44:47], v[212:215], v[80:95]
    ds_read_b64_tr_b16 v[36:37], v22 offset:32768
    ds_read_b64_tr_b16 v[38:39], v22 offset:33280
    s_add_u32 m0, s34, 147456
    s_lshl1_add_u32 s35, s54, 128
    buffer_load_dwordx4 v14, s[8:11], s35 offen offset:0  lds
    s_waitcnt lgkmcnt(4)
    v_mfma_f32_32x32x16_bf16 v[64:79], v[48:51], v[216:219], v[64:79]
    ds_read_b64_tr_b16 v[40:41], v19 offset:36864
    ds_read_b64_tr_b16 v[42:43], v19 offset:37376
    s_nop 0
    v_mfma_f32_32x32x16_bf16 v[80:95], v[52:55], v[216:219], v[80:95]
    ds_read_b64_tr_b16 v[44:45], v22 offset:36864
    ds_read_b64_tr_b16 v[46:47], v22 offset:37376
    buffer_load_dwordx4 v15, s[8:11], s35 offen offset:1024  lds
    v_mfma_f32_32x32x16_bf16 v[64:79], v[56:59], v[220:223], v[64:79]
    ds_read_b64_tr_b16 v[48:49], v19 offset:40960
    ds_read_b64_tr_b16 v[50:51], v19 offset:41472
    v_mfma_f32_32x32x16_bf16 v[80:95], v[60:63], v[220:223], v[80:95]
    ds_read_b64_tr_b16 v[52:53], v22 offset:40960
    ds_read_b64_tr_b16 v[54:55], v22 offset:41472
    buffer_load_dwordx4 v16, s[12:15], s35 offen offset:2048  lds
    s_waitcnt lgkmcnt(4)
    s_nop 0
    v_mfma_f32_32x32x16_bf16 v[64:79], v[32:35], v[224:227], v[64:79]
    ds_read_b64_tr_b16 v[56:57], v19 offset:45056
    ds_read_b64_tr_b16 v[58:59], v19 offset:45568
    v_mfma_f32_32x32x16_bf16 v[80:95], v[36:39], v[224:227], v[80:95]
    ds_read_b64_tr_b16 v[60:61], v22 offset:45056
    ds_read_b64_tr_b16 v[62:63], v22 offset:45568
    buffer_load_dwordx4 v17, s[12:15], s35 offen offset:3072  lds
    s_sub_u32 s44, s69, s30
    s_cmp_eq_u32 s44, 28
    s_cbranch_scc0 L_slow1
L_ok1:
    v_mfma_f32_32x32x16_bf16 v[64:79], v[40:43], v[228:231], v[64:79]
    s_waitcnt vmcnt(8)
    s_barrier
    ds_read_b64_tr_b16 v[32:33], v19 offset:49152
    s_nop 0
    ds_read_b64_tr_b16 v[34:35], v19 offset:49664
    v_mfma_f32_32x32x16_bf16 v[80:95], v[44:47], v[228:231], v[80:95]
    ds_read_b64_tr_b16 v[36:37], v22 offset:49152
    ds_read_b64_tr_b16 v[38:39], v22 offset:49664
    s_add_u32 m0, s34, 49152
    s_lshl1_add_u32 s35, s55, 128
    buffer_load_dwordx4 v14, s[8:11], s35 offen offset:0  lds
    s_waitcnt lgkmcnt(4)
    s_nop 0
    v_mfma_f32_32x32x16_bf16 v[64:79], v[48:51], v[232:235], v[64:79]
    ds_read_b64_tr_b16 v[40:41], v19 offset:53248
    ds_read_b64_tr_b16 v[42:43], v19 offset:53760
    v_mfma_f32_32x32x16_bf16 v[80:95], v[52:55], v[232:235], v[80:95]
    ds_read_b64_tr_b16 v[44:45], v22 offset:53248
    ds_read_b64_tr_b16 v[46:47], v22 offset:53760
    buffer_load_dwordx4 v15, s[8:11], s35 offen offset:1024  lds
    v_mfma_f32_32x32x16_bf16 v[64:79], v[56:59], v[236:239], v[64:79]
    ds_read_b64_tr_b16 v[48:49], v19 offset:57344
    ds_read_b64_tr_b16 v[50:51], v19 offset:57856
    v_mfma_f32_32x32x16_bf16 v[80:95], v[60:63], v[236:239], v[80:95]
    ds_read_b64_tr_b16 v[52:53], v22 offset:57344
    ds_read_b64_tr_b16 v[54:55], v22 offset:57856
    buffer_load_dwordx4 v16, s[12:15], s35 offen offset:2048  lds
    s_waitcnt lgkmcnt(4)
    v_mfma_f32_32x32x16_bf16 v[64:79], v[32:35], v[240:243], v[64:79]
    s_nop 0
    ds_read_b64_tr_b16 v[56:57], v19 offset:61440
    ds_read_b64_tr_b16 v[58:59], v19 offset:61952
    v_mfma_f32_32x32x16_bf16 v[80:95], v[36:39], v[240:243], v[80:95]
    ds_read_b64_tr_b16 v[60:61], v22 offset:61440
    ds_read_b64_tr_b16 v[62:63], v22 offset:61952
    buffer_load_dwordx4 v17, s[12:15], s35 offen offset:3072  lds
    v_mfma_f32_32x32x16_bf16 v[64:79], v[40:43], v[244:247], v[64:79]
    v_xor_b32 v18, 64, v18
    v_xor_b32 v19, 64, v19
    v_xor_b32 v20, 64, v20
    v_xor_b32 v21, 64, v21
    v_xor_b32 v22, 64, v22
    v_xor_b32 v23, 64, v23
    ds_read_b64_tr_b16 v[32:33], v18 offset:0
    ds_read_b64_tr_b16 v[34:35], v18 offset:512
    v_mfma_f32_32x32x16_bf16 v[80:95], v[44:47], v[244:247], v[80:95]
    ds_read_b64_tr_b16 v[36:37], v21 offset:0
    ds_read_b64_tr_b16 v[38:39], v21 offset:512
    s_lshl4_add_u32 s35, s46, 0
    buffer_load_dwordx4 a[0:3], v10, s[20:23], s35 offen sc1
    s_waitcnt lgkmcnt(4)
    v_mfma_f32_32x32x16_bf16 v[64:79], v[48:51], v[248:251], v[64:79]
    ds_read_b64_tr_b16 v[40:41], v18 offset:4096
    ds_read_b64_tr_b16 v[42:43], v18 offset:4608
    v_mfma_f32_32x32x16_bf16 v[80:95], v[52:55], v[248:251], v[80:95]
    ds_read_b64_tr_b16 v[44:45], v21 offset:4096
    ds_read_b64_tr_b16 v[46:47], v21 offset:4608
    buffer_load_dwordx4 a[4:7], v11, s[20:23], s35 offen sc1
    v_mfma_f32_32x32x16_bf16 v[64:79], v[56:59], v[252:255], v[64:79]
    ds_read_b64_tr_b16 v[48:49], v18 offset:8192
    ds_read_b64_tr_b16 v[50:51], v18 offset:8704
    v_mfma_f32_32x32x16_bf16 v[80:95], v[60:63], v[252:255], v[80:95]
    ds_read_b64_tr_b16 v[52:53], v21 offset:8192
    ds_read_b64_tr_b16 v[54:55], v21 offset:8704
    s_lshl4_add_u32 s35, s47, 0
    buffer_load_dwordx4 a[8:11], v10, s[20:23], s35 offen sc1
    s_waitcnt lgkmcnt(4)
    v_mfma_f32_32x32x16_bf16 v[96:111], v[32:35], v[144:147], 0
    ds_read_b64_tr_b16 v[56:57], v18 offset:12288
    ds_read_b64_tr_b16 v[58:59], v18 offset:12800
    v_mfma_f32_32x32x16_bf16 v[112:127], v[36:39], v[144:147], 0
    ds_read_b64_tr_b16 v[60:61], v21 offset:12288
    ds_read_b64_tr_b16 v[62:63], v21 offset:12800
    buffer_load_dwordx4 a[12:15], v11, s[20:23], s35 offen sc1
    v_mfma_f32_32x32x16_bf16 v[96:111], v[40:43], v[148:151], v[96:111]
    ds_read_b64_tr_b16 v[32:33], v18 offset:16384
    ds_read_b64_tr_b16 v[34:35], v18 offset:16896
    v_mul_f32 v64, v31, v64
    v_mul_f32 v65, v31, v65
    v_mul_f32 v66, v31, v66
    v_mul_f32 v67, v31, v67
    v_mfma_f32_32x32x16_bf16 v[112:127], v[44:47], v[148:151], v[112:127]
    ds_read_b64_tr_b16 v[36:37], v21 offset:16384
    ds_read_b64_tr_b16 v[38:39], v21 offset:16896
    s_lshl4_add_u32 s35, s48, 0
    buffer_load_dwordx4 a[16:19], v10, s[20:23], s35 offen sc1
    s_waitcnt lgkmcnt(4)
    v_mfma_f32_32x32x16_bf16 v[96:111], v[48:51], v[152:155], v[96:111]
    ds_read_b64_tr_b16 v[40:41], v18 offset:20480
    ds_read_b64_tr_b16 v[42:43], v18 offset:20992
    v_exp_f32 v64, v64
    v_exp_f32 v65, v65
    v_mfma_f32_32x32x16_bf16 v[112:127], v[52:55], v[152:155], v[112:127]
    ds_read_b64_tr_b16 v[44:45], v21 offset:20480
    ds_read_b64_tr_b16 v[46:47], v21 offset:20992
    buffer_load_dwordx4 a[20:23], v11, s[20:23], s35 offen sc1
    v_exp_f32_e64 v66, v66
    v_mfma_f32_32x32x16_bf16 v[96:111], v[56:59], v[156:159], v[96:111]
    ds_read_b64_tr_b16 v[48:49], v18 offset:24576
    ds_read_b64_tr_b16 v[50:51], v18 offset:25088
    v_exp_f32_e64 v67, v67
    v_fma_f32 v64, v64, v30, v30
    v_fma_f32 v65, v65, v30, v30
    v_mfma_f32_32x32x16_bf16 v[112:127], v[60:63], v[156:159], v[112:127]
    ds_read_b64_tr_b16 v[52:53], v21 offset:24576
    ds_read_b64_tr_b16 v[54:55], v21 offset:25088
    s_lshl4_add_u32 s35, s49, 0
    buffer_load_dwordx4 a[24:27], v10, s[20:23], s35 offen sc1
    v_fma_f32 v66, v66, v30, v30
    s_waitcnt lgkmcnt(4)
    v_mfma_f32_32x32x16_bf16 v[96:111], v[32:35], v[160:163], v[96:111]
    ds_read_b64_tr_b16 v[56:57], v18 offset:28672
    ds_read_b64_tr_b16 v[58:59], v18 offset:29184
    v_fma_f32 v67, v67, v30, v30
    v_rcp_f32_e64 v64, v64
    v_mfma_f32_32x32x16_bf16 v[112:127], v[36:39], v[160:163], v[112:127]
    ds_read_b64_tr_b16 v[60:61], v21 offset:28672
    ds_read_b64_tr_b16 v[62:63], v21 offset:29184
    buffer_load_dwordx4 a[28:31], v11, s[20:23], s35 offen sc1
    v_rcp_f32_e64 v65, v65
    v_mfma_f32_32x32x16_bf16 v[96:111], v[40:43], v[164:167], v[96:111]
    s_waitcnt vmcnt(12)
    s_barrier
    ds_read_b64_tr_b16 v[32:33], v18 offset:32768
    ds_read_b64_tr_b16 v[34:35], v18 offset:33280
    v_rcp_f32 v66, v66
    v_mfma_f32_32x32x16_bf16 v[112:127], v[44:47], v[164:167], v[112:127]
    ds_read_b64_tr_b16 v[36:37], v21 offset:32768
    ds_read_b64_tr_b16 v[38:39], v21 offset:33280
    s_add_u32 m0, s34, 0
    s_lshl1_add_u32 s35, s56, 128
    buffer_load_dwordx4 v14, s[8:11], s35 offen offset:0  lds
    s_waitcnt lgkmcnt(4)
    v_mfma_f32_32x32x16_bf16 v[96:111], v[48:51], v[168:171], v[96:111]
    s_nop 0
    ds_read_b64_tr_b16 v[40:41], v18 offset:36864
    ds_read_b64_tr_b16 v[42:43], v18 offset:37376
    v_rcp_f32 v67, v67
    v_mul_f32 v64, v64, v72
    v_mul_f32_e64 v65, v65, v73
    v_mfma_f32_32x32x16_bf16 v[112:127], v[52:55], v[168:171], v[112:127]
    ds_read_b64_tr_b16 v[44:45], v21 offset:36864
    ds_read_b64_tr_b16 v[46:47], v21 offset:37376
    buffer_load_dwordx4 v15, s[8:11], s35 offen offset:1024  lds
    v_mul_f32 v66, v66, v74
    v_mul_f32 v67, v67, v75
    v_cvt_pk_bf16_f32 v128, v64, v65
    v_mfma_f32_32x32x16_bf16 v[96:111], v[56:59], v[172:175], v[96:111]
    ds_read_b64_tr_b16 v[48:49], v18 offset:40960
    ds_read_b64_tr_b16 v[50:51], v18 offset:41472
    v_cvt_pk_bf16_f32 v129, v66, v67
    v_mul_f32 v68, v31, v68
    v_mul_f32 v69, v31, v69
    v_mul_f32_e64 v70, v31, v70
    v_mfma_f32_32x32x16_bf16 v[112:127], v[60:63], v[172:175], v[112:127]
    ds_read_b64_tr_b16 v[52:53], v21 offset:40960
    ds_read_b64_tr_b16 v[54:55], v21 offset:41472
    buffer_load_dwordx4 v16, s[12:15], s35 offen offset:2048  lds
    v_mul_f32 v71, v31, v71
    s_waitcnt lgkmcnt(4)
    v_mfma_f32_32x32x16_bf16 v[96:111], v[32:35], v[176:179], v[96:111]
    ds_read_b64_tr_b16 v[56:57], v18 offset:45056
    ds_read_b64_tr_b16 v[58:59], v18 offset:45568
    v_exp_f32 v68, v68
    v_exp_f32 v69, v69
    v_mfma_f32_32x32x16_bf16 v[112:127], v[36:39], v[176:179], v[112:127]
    ds_read_b64_tr_b16 v[60:61], v21 offset:45056
    ds_read_b64_tr_b16 v[62:63], v21 offset:45568
    buffer_load_dwordx4 v17, s[12:15], s35 offen offset:3072  lds
    v_exp_f32_e64 v70, v70
    v_mfma_f32_32x32x16_bf16 v[96:111], v[40:43], v[180:183], v[96:111]
    s_waitcnt vmcnt(12)
    s_barrier
    ds_read_b64_tr_b16 v[32:33], v19 offset:0
    ds_read_b64_tr_b16 v[34:35], v19 offset:512
    v_exp_f32_e64 v71, v71
    v_mfma_f32_32x32x16_bf16 v[112:127], v[44:47], v[180:183], v[112:127]
    ds_read_b64_tr_b16 v[36:37], v22 offset:0
    ds_read_b64_tr_b16 v[38:39], v22 offset:512
    s_add_u32 m0, s34, 16384
    s_lshl1_add_u32 s35, s57, 128
    buffer_load_dwordx4 v14, s[8:11], s35 offen offset:0  lds
    s_waitcnt lgkmcnt(4)
    v_mfma_f32_32x32x16_bf16 v[96:111], v[48:51], v[184:187], v[96:111]
    ds_read_b64_tr_b16 v[40:41], v19 offset:4096
    s_nop 0
    ds_read_b64_tr_b16 v[42:43], v19 offset:4608
    v_fma_f32 v68, v68, v30, v30
    v_fma_f32 v69, v69, v30, v30
    v_fma_f32 v70, v70, v30, v30
    v_fma_f32 v71, v71, v30, v30
    v_mfma_f32_32x32x16_bf16 v[112:127], v[52:55], v[184:187], v[112:127]
    ds_read_b64_tr_b16 v[44:45], v22 offset:4096
    ds_read_b64_tr_b16 v[46:47], v22 offset:4608
    buffer_load_dwordx4 v15, s[8:11], s35 offen offset:1024  lds
    v_rcp_f32_e64 v68, v68
    v_mfma_f32_32x32x16_bf16 v[96:111], v[56:59], v[188:191], v[96:111]
    ds_read_b64_tr_b16 v[48:49], v19 offset:8192
    ds_read_b64_tr_b16 v[50:51], v19 offset:8704
    v_rcp_f32 v69, v69
    v_rcp_f32 v70, v70
    v_mfma_f32_32x32x16_bf16 v[112:127], v[60:63], v[188:191], v[112:127]
    ds_read_b64_tr_b16 v[52:53], v22 offset:8192
    ds_read_b64_tr_b16 v[54:55], v22 offset:8704
    buffer_load_dwordx4 v16, s[12:15], s35 offen offset:2048  lds
    v_rcp_f32 v71, v71
    s_waitcnt lgkmcnt(4)
    v_mfma_f32_32x32x16_bf16 v[96:111], v[32:35], v[192:195], v[96:111]
    ds_read_b64_tr_b16 v[56:57], v19 offset:12288
    ds_read_b64_tr_b16 v[58:59], v19 offset:12800
    v_mul_f32 v68, v68, v76
    v_mul_f32 v69, v69, v77
    v_mul_f32 v70, v70, v78
    v_mul_f32 v71, v71, v79
    v_mfma_f32_32x32x16_bf16 v[112:127], v[36:39], v[192:195], v[112:127]
    ds_read_b64_tr_b16 v[60:61], v22 offset:12288
    ds_read_b64_tr_b16 v[62:63], v22 offset:12800
    buffer_load_dwordx4 v17, s[12:15], s35 offen offset:3072  lds
    v_cvt_pk_bf16_f32 v130, v68, v69
    v_cvt_pk_bf16_f32 v131, v70, v71
    v_mul_f32 v80, v31, v80
    v_mfma_f32_32x32x16_bf16 v[96:111], v[40:43], v[196:199], v[96:111]
    s_barrier
    ds_read_b64_tr_b16 v[32:33], v19 offset:16384
    ds_read_b64_tr_b16 v[34:35], v19 offset:16896
    v_mul_f32 v81, v31, v81
    v_mul_f32 v82, v31, v82
    v_mfma_f32_32x32x16_bf16 v[112:127], v[44:47], v[196:199], v[112:127]
    ds_read_b64_tr_b16 v[36:37], v22 offset:16384
    ds_read_b64_tr_b16 v[38:39], v22 offset:16896
    s_add_u32 m0, s34, 32768
    s_lshl1_add_u32 s35, s58, 128
    buffer_load_dwordx4 v14, s[8:11], s35 offen offset:0  lds
    s_waitcnt lgkmcnt(4)
    v_mfma_f32_32x32x16_bf16 v[96:111], v[48:51], v[200:203], v[96:111]
    ds_read_b64_tr_b16 v[40:41], v19 offset:20480
    s_nop 0
    ds_read_b64_tr_b16 v[42:43], v19 offset:20992
    v_mul_f32 v83, v31, v83
    v_exp_f32 v80, v80
    v_mfma_f32_32x32x16_bf16 v[112:127], v[52:55], v[200:203], v[112:127]
    ds_read_b64_tr_b16 v[44:45], v22 offset:20480
    ds_read_b64_tr_b16 v[46:47], v22 offset:20992
    buffer_load_dwordx4 v15, s[8:11], s35 offen offset:1024  lds
    v_exp_f32_e64 v81, v81
    v_mfma_f32_32x32x16_bf16 v[96:111], v[56:59], v[204:207], v[96:111]
    ds_read_b64_tr_b16 v[48:49], v19 offset:24576
    ds_read_b64_tr_b16 v[50:51], v19 offset:25088
    v_exp_f32 v82, v82
    v_exp_f32 v83, v83
    v_mfma_f32_32x32x16_bf16 v[112:127], v[60:63], v[204:207], v[112:127]
    ds_read_b64_tr_b16 v[52:53], v22 offset:24576
    ds_read_b64_tr_b16 v[54:55], v22 offset:25088
    buffer_load_dwordx4 v16, s[12:15], s35 offen offset:2048  lds
    v_fma_f32 v80, v80, v30, v30
    v_fma_f32 v81, v81, v30, v30
    s_waitcnt lgkmcnt(4)
    v_mfma_f32_32x32x16_bf16 v[96:111], v[32:35], v[208:211], v[96:111]
    ds_read_b64_tr_b16 v[56:57], v19 offset:28672
    ds_read_b64_tr_b16 v[58:59], v19 offset:29184
    v_fma_f32 v82, v82, v30, v30
    v_fma_f32 v83, v83, v30, v30
    v_rcp_f32 v80, v80
    v_mfma_f32_32x32x16_bf16 v[112:127], v[36:39], v[208:211], v[112:127]
    ds_read_b64_tr_b16 v[60:61], v22 offset:28672
    ds_read_b64_tr_b16 v[62:63], v22 offset:29184
    buffer_load_dwordx4 v17, s[12:15], s35 offen offset:3072  lds
    v_rcp_f32_e64 v81, v81
    v_mfma_f32_32x32x16_bf16 v[96:111], v[40:43], v[212:215], v[96:111]
    s_barrier
    ds_read_b64_tr_b16 v[32:33], v19 offset:32768
    ds_read_b64_tr_b16 v[34:35], v19 offset:33280
    v_rcp_f32 v82, v82
    v_mfma_f32_32x32x16_bf16 v[112:127], v[44:47], v[212:215], v[112:127]
    ds_read_b64_tr_b16 v[36:37], v22 offset:32768
    ds_read_b64_tr_b16 v[38:39], v22 offset:33280
    s_add_u32 m0, s34, 65536
    s_lshl1_add_u32 s35, s59, 128
    buffer_load_dwordx4 v14, s[8:11], s35 offen offset:0  lds
    s_waitcnt lgkmcnt(4)
    v_mfma_f32_32x32x16_bf16 v[96:111], v[48:51], v[216:219], v[96:111]
    s_nop 0
    ds_read_b64_tr_b16 v[40:41], v19 offset:36864
    ds_read_b64_tr_b16 v[42:43], v19 offset:37376
    v_rcp_f32 v83, v83
    v_mul_f32 v80, v80, v88
    v_mul_f32_e64 v81, v81, v89
    v_mfma_f32_32x32x16_bf16 v[112:127], v[52:55], v[216:219], v[112:127]
    ds_read_b64_tr_b16 v[44:45], v22 offset:36864
    ds_read_b64_tr_b16 v[46:47], v22 offset:37376
    buffer_load_dwordx4 v15, s[8:11], s35 offen offset:1024  lds
    v_mul_f32 v82, v82, v90
    v_mul_f32 v83, v83, v91
    v_cvt_pk_bf16_f32 v132, v80, v81
    v_mfma_f32_32x32x16_bf16 v[96:111], v[56:59], v[220:223], v[96:111]
    ds_read_b64_tr_b16 v[48:49], v19 offset:40960
L_padg2:
    s_cbranch_execz L_padg6
    ds_read_b64_tr_b16 v[50:51], v19 offset:41472
    v_cvt_pk_bf16_f32 v133, v82, v83
    v_mul_f32 v84, v31, v84
    v_mul_f32 v85, v31, v85
    v_mul_f32 v86, v31, v86
    v_mfma_f32_32x32x16_bf16 v[112:127], v[60:63], v[220:223], v[112:127]
    ds_read_b64_tr_b16 v[52:53], v22 offset:40960
    ds_read_b64_tr_b16 v[54:55], v22 offset:41472
    buffer_load_dwordx4 v16, s[12:15], s35 offen offset:2048  lds
    v_mul_f32 v87, v31, v87
    s_waitcnt lgkmcnt(4)
    v_mfma_f32_32x32x16_bf16 v[96:111], v[32:35], v[224:227], v[96:111]
    ds_read_b64_tr_b16 v[56:57], v19 offset:45056
    ds_read_b64_tr_b16 v[58:59], v19 offset:45568
    v_exp_f32 v84, v84
    v_exp_f32 v85, v85
    v_mfma_f32_32x32x16_bf16 v[112:127], v[36:39], v[224:227], v[112:127]
    ds_read_b64_tr_b16 v[60:61], v22 offset:45056
    ds_read_b64_tr_b16 v[62:63], v22 offset:45568
    buffer_load_dwordx4 v17, s[12:15], s35 offen offset:3072  lds
    v_exp_f32_e64 v86, v86
    v_mfma_f32_32x32x16_bf16 v[96:111], v[40:43], v[228:231], v[96:111]
    ds_read_b64_tr_b16 v[32:33], v19 offset:49152
    ds_read_b64_tr_b16 v[34:35], v19 offset:49664
    v_exp_f32_e64 v87, v87
    v_fma_f32 v84, v84, v30, v30
    v_fma_f32 v85, v85, v30, v30
    v_mfma_f32_32x32x16_bf16 v[112:127], v[44:47], v[228:231], v[112:127]
    ds_read_b64_tr_b16 v[36:37], v22 offset:49152
    ds_read_b64_tr_b16 v[38:39], v22 offset:49664
    s_lshl4_add_u32 s35, s50, 0
    buffer_load_dwordx4 a[32:35], v10, s[20:23], s35 offen sc1
    v_fma_f32 v86, v86, v30, v30
    s_waitcnt lgkmcnt(4)
    v_mfma_f32_32x32x16_bf16 v[96:111], v[48:51], v[232:235], v[96:111]
    ds_read_b64_tr_b16 v[40:41], v19 offset:53248
    ds_read_b64_tr_b16 v[42:43], v19 offset:53760
    v_fma_f32 v87, v87, v30, v30
    v_rcp_f32_e64 v84, v84
    v_mfma_f32_32x32x16_bf16 v[112:127], v[52:55], v[232:235], v[112:127]
    ds_read_b64_tr_b16 v[44:45], v22 offset:53248
    ds_read_b64_tr_b16 v[46:47], v22 offset:53760
    buffer_load_dwordx4 a[36:39], v11, s[20:23], s35 offen sc1
    v_rcp_f32_e64 v85, v85
    v_mfma_f32_32x32x16_bf16 v[96:111], v[56:59], v[236:239], v[96:111]
    ds_read_b64_tr_b16 v[48:49], v19 offset:57344
    ds_read_b64_tr_b16 v[50:51], v19 offset:57856
    v_rcp_f32 v86, v86
    v_rcp_f32 v87, v87
    v_mfma_f32_32x32x16_bf16 v[112:127], v[60:63], v[236:239], v[112:127]
    ds_read_b64_tr_b16 v[52:53], v22 offset:57344
    ds_read_b64_tr_b16 v[54:55], v22 offset:57856
    s_lshl4_add_u32 s35, s51, 0
    s_nop 0
    buffer_load_dwordx4 a[40:43], v10, s[20:23], s35 offen sc1
    v_mul_f32 v84, v84, v92
    s_waitcnt lgkmcnt(4)
    v_mfma_f32_32x32x16_bf16 v[96:111], v[32:35], v[240:243], v[96:111]
    ds_read_b64_tr_b16 v[56:57], v19 offset:61440
    ds_read_b64_tr_b16 v[58:59], v19 offset:61952
    v_mul_f32 v85, v85, v93
    v_mul_f32 v86, v86, v94
    v_mul_f32_e64 v87, v87, v95
    v_cvt_pk_bf16_f32 v134, v84, v85
    v_mfma_f32_32x32x16_bf16 v[112:127], v[36:39], v[240:243], v[112:127]
    ds_read_b64_tr_b16 v[60:61], v22 offset:61440
    ds_read_b64_tr_b16 v[62:63], v22 offset:61952
    buffer_load_dwordx4 a[44:47], v11, s[20:23], s35 offen sc1
    v_cvt_pk_bf16_f32 v135, v86, v87
    s_add_u32 s37, s60, 0
    v_mfma_f32_32x32x16_bf16 v[96:111], v[40:43], v[244:247], v[96:111]
    v_xor_b32 v18, 64, v18
    v_xor_b32 v19, 64, v19
    v_xor_b32 v20, 64, v20
    ds_read_b64_tr_b16 v[32:33], v20 offset:0
    ds_read_b64_tr_b16 v[34:35], v20 offset:512
    v_mfma_f32_32x32x16_bf16 v[112:127], v[44:47], v[244:247], v[112:127]
    ds_read_b64_tr_b16 v[36:37], v20 offset:4096
    ds_read_b64_tr_b16 v[38:39], v20 offset:4608
    s_lshl4_add_u32 s35, s52, 0
    buffer_load_dwordx4 a[48:51], v10, s[20:23], s35 offen sc1
    s_waitcnt lgkmcnt(4)
    v_mfma_f32_32x32x16_bf16 v[96:111], v[48:51], v[248:251], v[96:111]
    ds_read_b64_tr_b16 v[40:41], v20 offset:8192
    ds_read_b64_tr_b16 v[42:43], v20 offset:8704
    buffer_store_dwordx4 v[128:131], v24, s[20:23], s37 offen offset:0 sc1
    v_mfma_f32_32x32x16_bf16 v[112:127], v[52:55], v[248:251], v[112:127]
    ds_read_b64_tr_b16 v[44:45], v20 offset:12288
    ds_read_b64_tr_b16 v[46:47], v20 offset:12800
    buffer_load_dwordx4 a[52:55], v11, s[20:23], s35 offen sc1
    v_mfma_f32_32x32x16_bf16 v[96:111], v[56:59], v[252:255], v[96:111]
    ds_read_b64_tr_b16 v[48:49], v20 offset:16384
    ds_read_b64_tr_b16 v[50:51], v20 offset:16896
    buffer_store_dwordx4 v[132:135], v24, s[20:23], s37 offen offset:1024 sc1
    v_mfma_f32_32x32x16_bf16 v[112:127], v[60:63], v[252:255], v[112:127]
    ds_read_b64_tr_b16 v[52:53], v20 offset:20480
    ds_read_b64_tr_b16 v[54:55], v20 offset:20992
    s_lshl4_add_u32 s35, s46, 28672
    buffer_load_dwordx4 a[56:59], v10, s[20:23], s35 offen sc1
    s_waitcnt lgkmcnt(4)
    v_mfma_f32_32x32x16_bf16 v[64:79], v[32:35], v[144:147], 0
    ds_read_b64_tr_b16 v[56:57], v20 offset:24576
    ds_read_b64_tr_b16 v[58:59], v20 offset:25088
    s_nop 0
    v_mfma_f32_32x32x16_bf16 v[64:79], v[36:39], v[148:151], v[64:79]
    ds_read_b64_tr_b16 v[60:61], v20 offset:28672
    ds_read_b64_tr_b16 v[62:63], v20 offset:29184
    buffer_load_dwordx4 a[60:63], v11, s[20:23], s35 offen sc1
    v_mfma_f32_32x32x16_bf16 v[64:79], v[40:43], v[152:155], v[64:79]
    ds_read_b64_tr_b16 v[32:33], v18 offset:49152
    ds_read_b64_tr_b16 v[34:35], v18 offset:49664
    v_mul_f32 v96, v31, v96
    v_mul_f32 v97, v31, v97
    v_mul_f32 v98, v31, v98
    v_mul_f32 v99, v31, v99
    v_mfma_f32_32x32x16_bf16 v[64:79], v[44:47], v[156:159], v[64:79]
    ds_read_b64_tr_b16 v[36:37], v18 offset:53248
    ds_read_b64_tr_b16 v[38:39], v18 offset:53760
    s_lshl4_add_u32 s35, s47, 28672
    buffer_load_dwordx4 a[64:67], v10, s[20:23], s35 offen sc1
    v_exp_f32 v96, v96
    s_waitcnt lgkmcnt(4)
    v_mfma_f32_32x32x16_bf16 v[64:79], v[48:51], v[160:163], v[64:79]
    ds_read_b64_tr_b16 v[40:41], v18 offset:57344
    ds_read_b64_tr_b16 v[42:43], v18 offset:57856
    v_exp_f32 v97, v97
    v_exp_f32 v98, v98
    v_mfma_f32_32x32x16_bf16 v[64:79], v[52:55], v[164:167], v[64:79]
    ds_read_b64_tr_b16 v[44:45], v18 offset:61440
    ds_read_b64_tr_b16 v[46:47], v18 offset:61952
    buffer_load_dwordx4 a[68:71], v11, s[20:23], s35 offen sc1
    v_exp_f32_e64 v99, v99
    v_fma_f32 v96, v96, v30, v30
    v_fma_f32 v97, v97, v30, v30
    v_mfma_f32_32x32x16_bf16 v[64:79], v[56:59], v[168:171], v[64:79]
    s_waitcnt vmcnt(12)
    s_barrier
    ds_read_b64_tr_b16 v[48:49], v18 offset:0
    ds_read_b64_tr_b16 v[50:51], v18 offset:512
    v_fma_f32 v98, v98, v30, v30
    v_fma_f32 v99, v99, v30, v30
    v_mfma_f32_32x32x16_bf16 v[64:79], v[60:63], v[172:175], v[64:79]
    ds_read_b64_tr_b16 v[52:53], v18 offset:4096
    ds_read_b64_tr_b16 v[54:55], v18 offset:4608
    s_lshl4_add_u32 s35, s48, 28672
    buffer_load_dwordx4 a[72:75], v10, s[20:23], s35 offen sc1
    v_rcp_f32 v96, v96
    s_waitcnt lgkmcnt(4)
    v_mfma_f32_32x32x16_bf16 v[64:79], v[32:35], v[176:179], v[64:79]
    ds_read_b64_tr_b16 v[56:57], v18 offset:8192
    ds_read_b64_tr_b16 v[58:59], v18 offset:8704
    v_rcp_f32 v97, v97
    v_rcp_f32 v98, v98
    v_mfma_f32_32x32x16_bf16 v[64:79], v[36:39], v[180:183], v[64:79]
    ds_read_b64_tr_b16 v[60:61], v18 offset:12288
    ds_read_b64_tr_b16 v[62:63], v18 offset:12800
    buffer_load_dwordx4 a[76:79], v11, s[20:23], s35 offen sc1
    v_rcp_f32 v99, v99
    v_mul_f32 v96, v96, v104
    v_mul_f32_e64 v97, v97, v105
    v_mfma_f32_32x32x16_bf16 v[64:79], v[40:43], v[184:187], v[64:79]
    ds_read_b64_tr_b16 v[32:33], v18 offset:16384
    ds_read_b64_tr_b16 v[34:35], v18 offset:16896
    v_mul_f32 v98, v98, v106
    v_mul_f32 v99, v99, v107
    v_cvt_pk_bf16_f32 v136, v96, v97
    v_cvt_pk_bf16_f32 v137, v98, v99
    v_mul_f32_e64 v100, v31, v100
    v_mfma_f32_32x32x16_bf16 v[64:79], v[44:47], v[188:191], v[64:79]
    ds_read_b64_tr_b16 v[36:37], v18 offset:20480
    ds_read_b64_tr_b16 v[38:39], v18 offset:20992
    s_lshl4_add_u32 s35, s49, 28672
    buffer_load_dwordx4 a[80:83], v10, s[20:23], s35 offen sc1
    v_mul_f32 v101, v31, v101
    v_mul_f32_e64 v102, v31, v102
    s_waitcnt lgkmcnt(4)
    v_mfma_f32_32x32x16_bf16 v[64:79], v[48:51], v[192:195], v[64:79]
    ds_read_b64_tr_b16 v[40:41], v18 offset:24576
    ds_read_b64_tr_b16 v[42:43], v18 offset:25088
    v_mul_f32 v103, v31, v103
    v_exp_f32 v100, v100
    v_exp_f32_e64 v101, v101
    v_mfma_f32_32x32x16_bf16 v[64:79], v[52:55], v[196:199], v[64:79]
    ds_read_b64_tr_b16 v[44:45], v18 offset:28672
    ds_read_b64_tr_b16 v[46:47], v18 offset:29184
    buffer_load_dwordx4 a[84:87], v11, s[20:23], s35 offen sc1
    v_exp_f32 v102, v102
    v_exp_f32 v103, v103
    v_mfma_f32_32x32x16_bf16 v[64:79], v[56:59], v[200:203], v[64:79]
    ds_read_b64_tr_b16 v[48:49], v18 offset:32768
    ds_read_b64_tr_b16 v[50:51], v18 offset:33280
    v_fma_f32 v100, v100, v30, v30
    v_fma_f32 v101, v101, v30, v30
    v_fma_f32 v102, v102, v30, v30
    v_fma_f32 v103, v103, v30, v30
    v_mfma_f32_32x32x16_bf16 v[64:79], v[60:63], v[204:207], v[64:79]
    ds_read_b64_tr_b16 v[52:53], v18 offset:36864
    ds_read_b64_tr_b16 v[54:55], v18 offset:37376
    s_lshl4_add_u32 s35, s50, 28672
    buffer_load_dwordx4 a[88:91], v10, s[20:23], s35 offen sc1
    v_rcp_f32 v100, v100
    s_waitcnt lgkmcnt(4)
    v_mfma_f32_32x32x16_bf16 v[64:79], v[32:35], v[208:211], v[64:79]
    ds_read_b64_tr_b16 v[56:57], v18 offset:40960
    ds_read_b64_tr_b16 v[58:59], v18 offset:41472
    v_rcp_f32 v101, v101
    v_rcp_f32 v102, v102
    v_mfma_f32_32x32x16_bf16 v[64:79], v[36:39], v[212:215], v[64:79]
    ds_read_b64_tr_b16 v[60:61], v18 offset:45056
    ds_read_b64_tr_b16 v[62:63], v18 offset:45568
    buffer_load_dwordx4 a[92:95], v11, s[20:23], s35 offen sc1
    v_rcp_f32 v103, v103
    v_mul_f32 v100, v100, v108
    v_mul_f32_e64 v101, v101, v109
    v_mfma_f32_32x32x16_bf16 v[64:79], v[40:43], v[216:219], v[64:79]
    ds_read_b64_tr_b16 v[32:33], v19 offset:0
    ds_read_b64_tr_b16 v[34:35], v19 offset:512
    v_mul_f32 v102, v102, v110
    v_mul_f32 v103, v103, v111
    v_cvt_pk_bf16_f32 v138, v100, v101
    v_cvt_pk_bf16_f32 v139, v102, v103
    v_mul_f32_e64 v112, v31, v112
    v_mfma_f32_32x32x16_bf16 v[64:79], v[44:47], v[220:223], v[64:79]
    ds_read_b64_tr_b16 v[36:37], v19 offset:4096
    ds_read_b64_tr_b16 v[38:39], v19 offset:4608
    s_lshl4_add_u32 s35, s51, 28672
    buffer_load_dwordx4 a[96:99], v10, s[20:23], s35 offen sc1
    v_mul_f32 v113, v31, v113
    v_mul_f32 v114, v31, v114
    s_waitcnt lgkmcnt(4)
    v_mfma_f32_32x32x16_bf16 v[64:79], v[48:51], v[224:227], v[64:79]
    ds_read_b64_tr_b16 v[40:41], v19 offset:8192
    ds_read_b64_tr_b16 v[42:43], v19 offset:8704
    v_mul_f32 v115, v31, v115
    v_exp_f32 v112, v112
    v_exp_f32 v113, v113
    v_mfma_f32_32x32x16_bf16 v[64:79], v[52:55], v[228:231], v[64:79]
    ds_read_b64_tr_b16 v[44:45], v19 offset:12288
    ds_read_b64_tr_b16 v[46:47], v19 offset:12800
    buffer_load_dwordx4 a[100:103], v11, s[20:23], s35 offen sc1
    v_exp_f32 v114, v114
    v_exp_f32 v115, v115
    v_mfma_f32_32x32x16_bf16 v[64:79], v[56:59], v[232:235], v[64:79]
    v_xor_b32 v18, 32, v18
    v_xor_b32 v19, 32, v19
    v_xor_b32_e64 v20, 32, v20
    ds_read_b64_tr_b16 v[48:49], v20 offset:0
    ds_read_b64_tr_b16 v[50:51], v20 offset:512
    v_fma_f32 v112, v112, v30, v30
    v_fma_f32 v113, v113, v30, v30
    v_mfma_f32_32x32x16_bf16 v[64:79], v[60:63], v[236:239], v[64:79]
    ds_read_b64_tr_b16 v[52:53], v20 offset:4096
    ds_read_b64_tr_b16 v[54:55], v20 offset:4608
    s_lshl4_add_u32 s35, s52, 28672
    buffer_load_dwordx4 a[104:107], v10, s[20:23], s35 offen sc1
    v_fma_f32 v114, v114, v30, v30
    v_fma_f32 v115, v115, v30, v30
    s_waitcnt lgkmcnt(4)
    v_mfma_f32_32x32x16_bf16 v[64:79], v[32:35], v[240:243], v[64:79]
    ds_read_b64_tr_b16 v[56:57], v20 offset:8192
    ds_read_b64_tr_b16 v[58:59], v20 offset:8704
    v_rcp_f32 v112, v112
    v_rcp_f32_e64 v113, v113
    v_mfma_f32_32x32x16_bf16 v[64:79], v[36:39], v[244:247], v[64:79]
    ds_read_b64_tr_b16 v[60:61], v20 offset:12288
    ds_read_b64_tr_b16 v[62:63], v20 offset:12800
    buffer_load_dwordx4 a[108:111], v11, s[20:23], s35 offen sc1
    v_rcp_f32 v114, v114
    v_rcp_f32_e64 v115, v115
    v_mfma_f32_32x32x16_bf16 v[64:79], v[40:43], v[248:251], v[64:79]
    s_waitcnt vmcnt(14)
    s_atomic_add s67, s[20:21], s61 offset:131072
    ds_read_b64_tr_b16 v[32:33], v20 offset:16384
    ds_read_b64_tr_b16 v[34:35], v20 offset:16896
    v_mul_f32 v112, v112, v120
    v_mul_f32 v113, v113, v121
    v_mul_f32_e64 v114, v114, v122
    v_mfma_f32_32x32x16_bf16 v[64:79], v[44:47], v[252:255], v[64:79]
    ds_read_b64_tr_b16 v[36:37], v20 offset:20480
    ds_read_b64_tr_b16 v[38:39], v20 offset:20992
    s_lshl4_add_u32 s35, s46, 57344
    buffer_load_dwordx4 a[112:115], v10, s[20:23], s35 offen sc1
    v_mul_f32 v115, v115, v123
    v_cvt_pk_bf16_f32 v140, v112, v113
    s_waitcnt lgkmcnt(4)
    v_mfma_f32_32x32x16_bf16 v[80:95], v[48:51], v[144:147], 0
    ds_read_b64_tr_b16 v[40:41], v20 offset:24576
    ds_read_b64_tr_b16 v[42:43], v20 offset:25088
    v_cvt_pk_bf16_f32 v141, v114, v115
    v_mul_f32 v116, v31, v116
    v_mul_f32 v117, v31, v117
    v_mul_f32 v118, v31, v118
    v_mul_f32 v119, v31, v119
    v_mfma_f32_32x32x16_bf16 v[80:95], v[52:55], v[148:151], v[80:95]
    ds_read_b64_tr_b16 v[44:45], v20 offset:28672
    ds_read_b64_tr_b16 v[46:47], v20 offset:29184
    buffer_load_dwordx4 a[116:119], v11, s[20:23], s35 offen sc1
    v_exp_f32 v116, v116
    v_exp_f32 v117, v117
    v_mfma_f32_32x32x16_bf16 v[80:95], v[56:59], v[152:155], v[80:95]
    ds_read_b64_tr_b16 v[48:49], v18 offset:49152
    ds_read_b64_tr_b16 v[50:51], v18 offset:49664
    v_exp_f32 v118, v118
    v_exp_f32 v119, v119
    v_fma_f32 v116, v116, v30, v30
    v_mfma_f32_32x32x16_bf16 v[80:95], v[60:63], v[156:159], v[80:95]
    ds_read_b64_tr_b16 v[52:53], v18 offset:53248
    ds_read_b64_tr_b16 v[54:55], v18 offset:53760
    s_lshl4_add_u32 s35, s47, 57344
    buffer_load_dwordx4 a[120:123], v10, s[20:23], s35 offen sc1
    v_fma_f32 v117, v117, v30, v30
    v_fma_f32 v118, v118, v30, v30
    s_waitcnt lgkmcnt(4)
    s_nop 0
    v_mfma_f32_32x32x16_bf16 v[80:95], v[32:35], v[160:163], v[80:95]
    ds_read_b64_tr_b16 v[56:57], v18 offset:57344
    ds_read_b64_tr_b16 v[58:59], v18 offset:57856
    v_fma_f32 v119, v119, v30, v30
    v_rcp_f32 v116, v116
    v_rcp_f32 v117, v117
    v_mfma_f32_32x32x16_bf16 v[80:95], v[36:39], v[164:167], v[80:95]
    ds_read_b64_tr_b16 v[60:61], v18 offset:61440
    ds_read_b64_tr_b16 v[62:63], v18 offset:61952
    buffer_load_dwordx4 a[124:127], v11, s[20:23], s35 offen sc1
    v_rcp_f32 v118, v118
    v_rcp_f32 v119, v119
    v_mfma_f32_32x32x16_bf16 v[80:95], v[40:43], v[168:171], v[80:95]
    ds_read_b64_tr_b16 v[32:33], v18 offset:0
    ds_read_b64_tr_b16 v[34:35], v18 offset:512
    v_mul_f32 v116, v116, v124
    v_mul_f32 v117, v117, v125
    v_mul_f32 v118, v118, v126
    v_mul_f32 v119, v119, v127
    v_cvt_pk_bf16_f32 v142, v116, v117
    v_mfma_f32_32x32x16_bf16 v[80:95], v[44:47], v[172:175], v[80:95]
    ds_read_b64_tr_b16 v[36:37], v18 offset:4096
    ds_read_b64_tr_b16 v[38:39], v18 offset:4608
    s_lshl4_add_u32 s35, s48, 57344
    buffer_load_dwordx4 a[128:131], v10, s[20:23], s35 offen sc1
    v_cvt_pk_bf16_f32 v143, v118, v119
    s_add_u32 s37, s60, 28672
    s_waitcnt lgkmcnt(4)
    s_nop 0
    v_mfma_f32_32x32x16_bf16 v[80:95], v[48:51], v[176:179], v[80:95]
    ds_read_b64_tr_b16 v[40:41], v18 offset:8192
    ds_read_b64_tr_b16 v[42:43], v18 offset:8704
    buffer_store_dwordx4 v[136:139], v24, s[20:23], s37 offen offset:0 sc1
    v_mfma_f32_32x32x16_bf16 v[80:95], v[52:55], v[180:183], v[80:95]
    ds_read_b64_tr_b16 v[44:45], v18 offset:12288
    ds_read_b64_tr_b16 v[46:47], v18 offset:12800
    buffer_load_dwordx4 a[132:135], v11, s[20:23], s35 offen sc1
    buffer_store_dwordx4 v[140:143], v24, s[20:23], s37 offen offset:1024 sc1
    v_mfma_f32_32x32x16_bf16 v[80:95], v[56:59], v[184:187], v[80:95]
    ds_read_b64_tr_b16 v[48:49], v18 offset:16384
    ds_read_b64_tr_b16 v[50:51], v18 offset:16896
    v_mul_f32 v64, v31, v64
    v_mul_f32 v65, v31, v65
    v_mul_f32 v66, v31, v66
    v_mul_f32 v67, v31, v67
    v_mfma_f32_32x32x16_bf16 v[80:95], v[60:63], v[188:191], v[80:95]
    ds_read_b64_tr_b16 v[52:53], v18 offset:20480
    ds_read_b64_tr_b16 v[54:55], v18 offset:20992
    s_lshl4_add_u32 s35, s49, 57344
    buffer_load_dwordx4 a[136:139], v10, s[20:23], s35 offen sc1
    v_exp_f32 v64, v64
    s_waitcnt lgkmcnt(4)
    v_mfma_f32_32x32x16_bf16 v[80:95], v[32:35], v[192:195], v[80:95]
    ds_read_b64_tr_b16 v[56:57], v18 offset:24576
    ds_read_b64_tr_b16 v[58:59], v18 offset:25088
    v_exp_f32 v65, v65
    v_exp_f32 v66, v66
    v_mfma_f32_32x32x16_bf16 v[80:95], v[36:39], v[196:199], v[80:95]
    ds_read_b64_tr_b16 v[60:61], v18 offset:28672
    ds_read_b64_tr_b16 v[62:63], v18 offset:29184
    buffer_load_dwordx4 a[140:143], v11, s[20:23], s35 offen sc1
    v_exp_f32_e64 v67, v67
    v_fma_f32 v64, v64, v30, v30
    v_fma_f32 v65, v65, v30, v30
    v_mfma_f32_32x32x16_bf16 v[80:95], v[40:43], v[200:203], v[80:95]
    ds_read_b64_tr_b16 v[32:33], v18 offset:32768
    ds_read_b64_tr_b16 v[34:35], v18 offset:33280
    v_fma_f32 v66, v66, v30, v30
    v_fma_f32 v67, v67, v30, v30
    v_rcp_f32_e64 v64, v64
    v_mfma_f32_32x32x16_bf16 v[80:95], v[44:47], v[204:207], v[80:95]
    ds_read_b64_tr_b16 v[36:37], v18 offset:36864
    ds_read_b64_tr_b16 v[38:39], v18 offset:37376
    s_lshl4_add_u32 s35, s50, 57344
    buffer_load_dwordx4 a[144:147], v10, s[20:23], s35 offen sc1
    v_rcp_f32 v65, v65
    s_waitcnt lgkmcnt(4)
    v_mfma_f32_32x32x16_bf16 v[80:95], v[48:51], v[208:211], v[80:95]
    ds_read_b64_tr_b16 v[40:41], v18 offset:40960
    ds_read_b64_tr_b16 v[42:43], v18 offset:41472
    v_rcp_f32 v66, v66
    v_rcp_f32 v67, v67
    v_mul_f32_e64 v64, v64, v72
    v_mfma_f32_32x32x16_bf16 v[80:95], v[52:55], v[212:215], v[80:95]
    ds_read_b64_tr_b16 v[44:45], v18 offset:45056
    ds_read_b64_tr_b16 v[46:47], v18 offset:45568
    buffer_load_dwordx4 a[148:151], v11, s[20:23], s35 offen sc1
    v_mul_f32 v65, v65, v73
    v_mul_f32 v66, v66, v74
    v_mul_f32_e64 v67, v67, v75
    v_cvt_pk_bf16_f32 v128, v64, v65
    v_mfma_f32_32x32x16_bf16 v[80:95], v[56:59], v[216:219], v[80:95]
    ds_read_b64_tr_b16 v[48:49], v19 offset:0
    ds_read_b64_tr_b16 v[50:51], v19 offset:512
    v_cvt_pk_bf16_f32 v129, v66, v67
    v_mul_f32 v68, v31, v68
    v_mul_f32 v69, v31, v69
    v_mul_f32 v70, v31, v70
    v_mul_f32 v71, v31, v71
    v_mfma_f32_32x32x16_bf16 v[80:95], v[60:63], v[220:223], v[80:95]
    ds_read_b64_tr_b16 v[52:53], v19 offset:4096
    ds_read_b64_tr_b16 v[54:55], v19 offset:4608
    s_lshl4_add_u32 s35, s51, 57344
    buffer_load_dwordx4 a[152:155], v10, s[20:23], s35 offen sc1
    v_exp_f32 v68, v68
    s_waitcnt lgkmcnt(4)
    v_mfma_f32_32x32x16_bf16 v[80:95], v[32:35], v[224:227], v[80:95]
    ds_read_b64_tr_b16 v[56:57], v19 offset:8192
    ds_read_b64_tr_b16 v[58:59], v19 offset:8704
    v_exp_f32 v69, v69
    v_exp_f32 v70, v70
    v_mfma_f32_32x32x16_bf16 v[80:95], v[36:39], v[228:231], v[80:95]
    ds_read_b64_tr_b16 v[60:61], v19 offset:12288
    ds_read_b64_tr_b16 v[62:63], v19 offset:12800
    buffer_load_dwordx4 a[156:159], v11, s[20:23], s35 offen sc1
    v_exp_f32_e64 v71, v71
    v_fma_f32 v68, v68, v30, v30
    v_mfma_f32_32x32x16_bf16 v[80:95], v[40:43], v[232:235], v[80:95]
    v_xor_b32 v18, 96, v18
    v_xor_b32 v19, 96, v19
    v_xor_b32 v20, 96, v20
    ds_read_b64_tr_b16 v[32:33], v20 offset:0
    ds_read_b64_tr_b16 v[34:35], v20 offset:512
    v_fma_f32 v69, v69, v30, v30
    v_mfma_f32_32x32x16_bf16 v[80:95], v[44:47], v[236:239], v[80:95]
    ds_read_b64_tr_b16 v[36:37], v20 offset:4096
    ds_read_b64_tr_b16 v[38:39], v20 offset:4608
    s_lshl4_add_u32 s35, s52, 57344
    buffer_load_dwordx4 a[160:163], v10, s[20:23], s35 offen sc1
    v_fma_f32 v70, v70, v30, v30
    s_waitcnt lgkmcnt(4)
    v_mfma_f32_32x32x16_bf16 v[80:95], v[48:51], v[240:243], v[80:95]
    ds_read_b64_tr_b16 v[40:41], v20 offset:8192
    ds_read_b64_tr_b16 v[42:43], v20 offset:8704
    v_fma_f32 v71, v71, v30, v30
    v_rcp_f32 v68, v68
    v_mfma_f32_32x32x16_bf16 v[80:95], v[52:55], v[244:247], v[80:95]
    ds_read_b64_tr_b16 v[44:45], v20 offset:12288
    ds_read_b64_tr_b16 v[46:47], v20 offset:12800
    buffer_load_dwordx4 a[164:167], v11, s[20:23], s35 offen sc1
    v_rcp_f32_e64 v69, v69
    v_mfma_f32_32x32x16_bf16 v[80:95], v[56:59], v[248:251], v[80:95]
    s_mov_b32 s68, 0
    s_atomic_add s68, s[20:21], s62 offset:131072 glc
    ds_read_b64_tr_b16 v[48:49], v20 offset:16384
    ds_read_b64_tr_b16 v[50:51], v20 offset:16896
    v_rcp_f32 v70, v70
    v_mfma_f32_32x32x16_bf16 v[80:95], v[60:63], v[252:255], v[80:95]
    ds_read_b64_tr_b16 v[52:53], v20 offset:20480
    ds_read_b64_tr_b16 v[54:55], v20 offset:20992
    s_lshl4_add_u32 s35, s46, 86016
    buffer_load_dwordx4 a[168:171], v10, s[20:23], s35 offen sc1
    s_waitcnt lgkmcnt(4)
    v_mfma_f32_32x32x16_bf16 v[96:111], v[32:35], v[144:147], 0
    s_nop 0
    ds_read_b64_tr_b16 v[56:57], v20 offset:24576
    ds_read_b64_tr_b16 v[58:59], v20 offset:25088
    v_rcp_f32 v71, v71
    v_mul_f32 v68, v68, v76
    v_mul_f32 v69, v69, v77
    v_mul_f32 v70, v70, v78
    v_mfma_f32_32x32x16_bf16 v[96:111], v[36:39], v[148:151], v[96:111]
    ds_read_b64_tr_b16 v[60:61], v20 offset:28672
    ds_read_b64_tr_b16 v[62:63], v20 offset:29184
    buffer_load_dwordx4 a[172:175], v11, s[20:23], s35 offen sc1
    v_mul_f32 v71, v71, v79
    v_cvt_pk_bf16_f32 v130, v68, v69
    v_cvt_pk_bf16_f32 v131, v70, v71
    v_mfma_f32_32x32x16_bf16 v[96:111], v[40:43], v[152:155], v[96:111]
    s_waitcnt vmcnt(10)
    s_atomic_add s67, s[20:21], s61 offset:131584
    ds_read_b64_tr_b16 v[32:33], v18 offset:49152
    ds_read_b64_tr_b16 v[34:35], v18 offset:49664
    v_mul_f32 v80, v31, v80
    v_mul_f32 v81, v31, v81
    v_mul_f32_e64 v82, v31, v82
    v_mfma_f32_32x32x16_bf16 v[96:111], v[44:47], v[156:159], v[96:111]
    ds_read_b64_tr_b16 v[36:37], v18 offset:53248
    ds_read_b64_tr_b16 v[38:39], v18 offset:53760
    s_lshl4_add_u32 s35, s47, 86016
    buffer_load_dwordx4 a[176:179], v10, s[20:23], s35 offen sc1
    v_mul_f32 v83, v31, v83
    s_waitcnt lgkmcnt(4)
    v_mfma_f32_32x32x16_bf16 v[96:111], v[48:51], v[160:163], v[96:111]
    ds_read_b64_tr_b16 v[40:41], v18 offset:57344
    ds_read_b64_tr_b16 v[42:43], v18 offset:57856
    v_exp_f32 v80, v80
    v_exp_f32 v81, v81
    v_mfma_f32_32x32x16_bf16 v[96:111], v[52:55], v[164:167], v[96:111]
    ds_read_b64_tr_b16 v[44:45], v18 offset:61440
    ds_read_b64_tr_b16 v[46:47], v18 offset:61952
    buffer_load_dwordx4 a[180:183], v11, s[20:23], s35 offen sc1
    v_exp_f32 v82, v82
    v_exp_f32 v83, v83
    v_mfma_f32_32x32x16_bf16 v[96:111], v[56:59], v[168:171], v[96:111]
    ds_read_b64_tr_b16 v[48:49], v18 offset:0
    ds_read_b64_tr_b16 v[50:51], v18 offset:512
    v_fma_f32 v80, v80, v30, v30
    v_fma_f32 v81, v81, v30, v30
    v_fma_f32 v82, v82, v30, v30
    v_fma_f32 v83, v83, v30, v30
    v_mfma_f32_32x32x16_bf16 v[96:111], v[60:63], v[172:175], v[96:111]
    ds_read_b64_tr_b16 v[52:53], v18 offset:4096
    ds_read_b64_tr_b16 v[54:55], v18 offset:4608
    s_lshl4_add_u32 s35, s48, 86016
    buffer_load_dwordx4 a[184:187], v10, s[20:23], s35 offen sc1
    v_rcp_f32 v80, v80
    s_waitcnt lgkmcnt(4)
    v_mfma_f32_32x32x16_bf16 v[96:111], v[32:35], v[176:179], v[96:111]
    ds_read_b64_tr_b16 v[56:57], v18 offset:8192
    ds_read_b64_tr_b16 v[58:59], v18 offset:8704
    v_rcp_f32 v81, v81
    v_rcp_f32 v82, v82
    v_mfma_f32_32x32x16_bf16 v[96:111], v[36:39], v[180:183], v[96:111]
    ds_read_b64_tr_b16 v[60:61], v18 offset:12288
    ds_read_b64_tr_b16 v[62:63], v18 offset:12800
    buffer_load_dwordx4 a[188:191], v11, s[20:23], s35 offen sc1
    v_rcp_f32 v83, v83
    v_mul_f32 v80, v80, v88
    v_mul_f32_e64 v81, v81, v89
    v_mfma_f32_32x32x16_bf16 v[96:111], v[40:43], v[184:187], v[96:111]
    ds_read_b64_tr_b16 v[32:33], v18 offset:16384
    ds_read_b64_tr_b16 v[34:35], v18 offset:16896
    v_mul_f32 v82, v82, v90
    v_mul_f32 v83, v83, v91
    v_cvt_pk_bf16_f32 v132, v80, v81
    v_cvt_pk_bf16_f32 v133, v82, v83
    v_mul_f32_e64 v84, v31, v84
    v_mfma_f32_32x32x16_bf16 v[96:111], v[44:47], v[188:191], v[96:111]
    ds_read_b64_tr_b16 v[36:37], v18 offset:20480
    ds_read_b64_tr_b16 v[38:39], v18 offset:20992
    s_lshl4_add_u32 s35, s49, 86016
    buffer_load_dwordx4 a[192:195], v10, s[20:23], s35 offen sc1
    v_mul_f32 v85, v31, v85
    v_mul_f32 v86, v31, v86
    s_waitcnt lgkmcnt(4)
    v_mfma_f32_32x32x16_bf16 v[96:111], v[48:51], v[192:195], v[96:111]
    ds_read_b64_tr_b16 v[40:41], v18 offset:24576
    ds_read_b64_tr_b16 v[42:43], v18 offset:25088
    v_mul_f32 v87, v31, v87
    v_exp_f32 v84, v84
    v_exp_f32 v85, v85
    v_mfma_f32_32x32x16_bf16 v[96:111], v[52:55], v[196:199], v[96:111]
    ds_read_b64_tr_b16 v[44:45], v18 offset:28672
    ds_read_b64_tr_b16 v[46:47], v18 offset:29184
    buffer_load_dwordx4 a[196:199], v11, s[20:23], s35 offen sc1
    v_exp_f32 v86, v86
    v_exp_f32 v87, v87
    v_mfma_f32_32x32x16_bf16 v[96:111], v[56:59], v[200:203], v[96:111]
    ds_read_b64_tr_b16 v[48:49], v18 offset:32768
    ds_read_b64_tr_b16 v[50:51], v18 offset:33280
    v_fma_f32 v84, v84, v30, v30
    v_fma_f32 v85, v85, v30, v30
    v_fma_f32 v86, v86, v30, v30
    v_fma_f32 v87, v87, v30, v30
    v_mfma_f32_32x32x16_bf16 v[96:111], v[60:63], v[204:207], v[96:111]
    ds_read_b64_tr_b16 v[52:53], v18 offset:36864
    ds_read_b64_tr_b16 v[54:55], v18 offset:37376
    s_lshl4_add_u32 s35, s50, 86016
    buffer_load_dwordx4 a[200:203], v10, s[20:23], s35 offen sc1
    v_rcp_f32 v84, v84
    s_sub_u32 s44, s68, s30
    s_cmp_eq_u32 s44, 14
    s_cbranch_scc0 L_slow2
L_ok2:
    s_waitcnt lgkmcnt(4)
    v_mfma_f32_32x32x16_bf16 v[96:111], v[32:35], v[208:211], v[96:111]
    ds_read_b64_tr_b16 v[56:57], v18 offset:40960
    ds_read_b64_tr_b16 v[58:59], v18 offset:41472
    v_rcp_f32 v85, v85
    v_rcp_f32_e64 v86, v86
    v_mfma_f32_32x32x16_bf16 v[96:111], v[36:39], v[212:215], v[96:111]
    ds_read_b64_tr_b16 v[60:61], v18 offset:45056
    ds_read_b64_tr_b16 v[62:63], v18 offset:45568
    buffer_load_dwordx4 a[204:207], v11, s[20:23], s35 offen sc1
    v_rcp_f32 v87, v87
    v_mul_f32 v84, v84, v92
    v_mul_f32_e64 v85, v85, v93
    v_mfma_f32_32x32x16_bf16 v[96:111], v[40:43], v[216:219], v[96:111]
    ds_read_b64_tr_b16 v[32:33], v19 offset:0
L_padg3:
    s_cbranch_execz L_padg7
    ds_read_b64_tr_b16 v[34:35], v19 offset:512
    v_mul_f32 v86, v86, v94
    v_mul_f32_e64 v87, v87, v95
    v_cvt_pk_bf16_f32 v134, v84, v85
    v_cvt_pk_bf16_f32 v135, v86, v87
    s_add_u32 s37, s60, 57344
    v_mfma_f32_32x32x16_bf16 v[96:111], v[44:47], v[220:223], v[96:111]
    ds_read_b64_tr_b16 v[36:37], v19 offset:4096
    ds_read_b64_tr_b16 v[38:39], v19 offset:4608
    s_lshl4_add_u32 s35, s51, 86016
    buffer_load_dwordx4 a[208:211], v10, s[20:23], s35 offen sc1
    s_waitcnt lgkmcnt(4)
    v_mfma_f32_32x32x16_bf16 v[96:111], v[48:51], v[224:227], v[96:111]
    ds_read_b64_tr_b16 v[40:41], v19 offset:8192
    ds_read_b64_tr_b16 v[42:43], v19 offset:8704
    s_nop 0
    buffer_store_dwordx4 v[128:131], v24, s[20:23], s37 offen offset:0 sc1
    v_mfma_f32_32x32x16_bf16 v[96:111], v[52:55], v[228:231], v[96:111]
    ds_read_b64_tr_b16 v[44:45], v19 offset:12288
    ds_read_b64_tr_b16 v[46:47], v19 offset:12800
    buffer_load_dwordx4 a[212:215], v11, s[20:23], s35 offen sc1
    buffer_store_dwordx4 v[132:135], v24, s[20:23], s37 offen offset:1024 sc1
    v_mfma_f32_32x32x16_bf16 v[96:111], v[56:59], v[232:235], v[96:111]
    s_mov_b32 s68, 0
    s_atomic_add s68, s[20:21], s62 offset:131584 glc
    v_xor_b32 v18, 32, v18
    v_xor_b32 v19, 32, v19
    v_xor_b32 v20, 32, v20
    ds_read_b64_tr_b16 v[48:49], v20 offset:0
    ds_read_b64_tr_b16 v[50:51], v20 offset:512
    v_mfma_f32_32x32x16_bf16 v[96:111], v[60:63], v[236:239], v[96:111]
    ds_read_b64_tr_b16 v[52:53], v20 offset:4096
    ds_read_b64_tr_b16 v[54:55], v20 offset:4608
    s_lshl4_add_u32 s35, s52, 86016
    buffer_load_dwordx4 a[216:219], v10, s[20:23], s35 offen sc1
    s_waitcnt lgkmcnt(4)
    v_mfma_f32_32x32x16_bf16 v[96:111], v[32:35], v[240:243], v[96:111]
    ds_read_b64_tr_b16 v[56:57], v20 offset:8192
    s_nop 0
    ds_read_b64_tr_b16 v[58:59], v20 offset:8704
    v_mfma_f32_32x32x16_bf16 v[96:111], v[36:39], v[244:247], v[96:111]
    ds_read_b64_tr_b16 v[60:61], v20 offset:12288
    ds_read_b64_tr_b16 v[62:63], v20 offset:12800
    buffer_load_dwordx4 a[220:223], v11, s[20:23], s35 offen sc1
    v_mfma_f32_32x32x16_bf16 v[96:111], v[40:43], v[248:251], v[96:111]
    ds_read_b64_tr_b16 v[32:33], v20 offset:16384
    ds_read_b64_tr_b16 v[34:35], v20 offset:16896
    v_mfma_f32_32x32x16_bf16 v[96:111], v[44:47], v[252:255], v[96:111]
    ds_read_b64_tr_b16 v[36:37], v20 offset:20480
    ds_read_b64_tr_b16 v[38:39], v20 offset:20992
    s_waitcnt lgkmcnt(4)
    s_nop 0
    v_mfma_f32_32x32x16_bf16 v[112:127], v[48:51], v[144:147], 0
    ds_read_b64_tr_b16 v[40:41], v20 offset:24576
    ds_read_b64_tr_b16 v[42:43], v20 offset:25088
    v_mfma_f32_32x32x16_bf16 v[112:127], v[52:55], v[148:151], v[112:127]
    ds_read_b64_tr_b16 v[44:45], v20 offset:28672
    ds_read_b64_tr_b16 v[46:47], v20 offset:29184
    s_lshl4_add_u32 s35, s46, 0
    buffer_load_dwordx4 v[144:147], v12, s[20:23], s35 offen sc1
    v_mfma_f32_32x32x16_bf16 v[112:127], v[56:59], v[152:155], v[112:127]
    s_barrier
    ds_read_b64_tr_b16 v[48:49], v18 offset:49152
    ds_read_b64_tr_b16 v[50:51], v18 offset:49664
    v_mul_f32 v96, v31, v96
    v_mul_f32 v97, v31, v97
    v_mul_f32_e64 v98, v31, v98
    v_mfma_f32_32x32x16_bf16 v[112:127], v[60:63], v[156:159], v[112:127]
    ds_read_b64_tr_b16 v[52:53], v18 offset:53248
    ds_read_b64_tr_b16 v[54:55], v18 offset:53760
    buffer_load_dwordx4 v[148:151], v13, s[20:23], s35 offen sc1
    v_mul_f32 v99, v31, v99
    v_exp_f32_e64 v96, v96
    s_waitcnt lgkmcnt(4)
    v_mfma_f32_32x32x16_bf16 v[112:127], v[32:35], v[160:163], v[112:127]
    ds_read_b64_tr_b16 v[56:57], v18 offset:57344
    ds_read_b64_tr_b16 v[58:59], v18 offset:57856
    v_exp_f32 v97, v97
    v_exp_f32 v98, v98
    v_mfma_f32_32x32x16_bf16 v[112:127], v[36:39], v[164:167], v[112:127]
    ds_read_b64_tr_b16 v[60:61], v18 offset:61440
    ds_read_b64_tr_b16 v[62:63], v18 offset:61952
    s_lshl4_add_u32 s35, s47, 0
    buffer_load_dwordx4 v[152:155], v12, s[20:23], s35 offen sc1
    v_exp_f32 v99, v99
    v_fma_f32 v96, v96, v30, v30
    v_mfma_f32_32x32x16_bf16 v[112:127], v[40:43], v[168:171], v[112:127]
    ds_read_b64_tr_b16 v[32:33], v18 offset:0
    ds_read_b64_tr_b16 v[34:35], v18 offset:512
    v_fma_f32 v97, v97, v30, v30
    v_fma_f32 v98, v98, v30, v30
    v_fma_f32 v99, v99, v30, v30
    v_rcp_f32_e64 v96, v96
    v_mfma_f32_32x32x16_bf16 v[112:127], v[44:47], v[172:175], v[112:127]
    ds_read_b64_tr_b16 v[36:37], v18 offset:4096
    ds_read_b64_tr_b16 v[38:39], v18 offset:4608
    buffer_load_dwordx4 v[156:159], v13, s[20:23], s35 offen sc1
    v_rcp_f32 v97, v97
    s_waitcnt lgkmcnt(4)
    v_mfma_f32_32x32x16_bf16 v[112:127], v[48:51], v[176:179], v[112:127]
    ds_read_b64_tr_b16 v[40:41], v18 offset:8192
    ds_read_b64_tr_b16 v[42:43], v18 offset:8704
    v_rcp_f32 v98, v98
    v_rcp_f32 v99, v99
    v_mul_f32_e64 v96, v96, v104
    v_mfma_f32_32x32x16_bf16 v[112:127], v[52:55], v[180:183], v[112:127]
    ds_read_b64_tr_b16 v[44:45], v18 offset:12288
    ds_read_b64_tr_b16 v[46:47], v18 offset:12800
    s_lshl4_add_u32 s35, s48, 0
    buffer_load_dwordx4 v[160:163], v12, s[20:23], s35 offen sc1
    v_mul_f32 v97, v97, v105
    v_mul_f32 v98, v98, v106
    v_mul_f32 v99, v99, v107
    v_mfma_f32_32x32x16_bf16 v[112:127], v[56:59], v[184:187], v[112:127]
    ds_read_b64_tr_b16 v[48:49], v18 offset:16384
    ds_read_b64_tr_b16 v[50:51], v18 offset:16896
    v_cvt_pk_bf16_f32 v136, v96, v97
    v_cvt_pk_bf16_f32 v137, v98, v99
    v_mul_f32 v100, v31, v100
    v_mul_f32 v101, v31, v101
    v_mul_f32_e64 v102, v31, v102
    v_mfma_f32_32x32x16_bf16 v[112:127], v[60:63], v[188:191], v[112:127]
    ds_read_b64_tr_b16 v[52:53], v18 offset:20480
    ds_read_b64_tr_b16 v[54:55], v18 offset:20992
    buffer_load_dwordx4 v[164:167], v13, s[20:23], s35 offen sc1
    v_mul_f32 v103, v31, v103
    v_exp_f32 v100, v100
    s_sub_u32 s44, s68, s30
    s_cmp_eq_u32 s44, 14
    s_cbranch_scc0 L_slow3
L_ok3:
    s_waitcnt lgkmcnt(4)
    v_mfma_f32_32x32x16_bf16 v[112:127], v[32:35], v[192:195], v[112:127]
    s_mov_b32 s69, 0
    s_atomic_add s69, s[20:21], s18 offset:133632 glc
    ds_read_b64_tr_b16 v[56:57], v18 offset:24576
    ds_read_b64_tr_b16 v[58:59], v18 offset:25088
    v_exp_f32 v101, v101
    v_mfma_f32_32x32x16_bf16 v[112:127], v[36:39], v[196:199], v[112:127]
    ds_read_b64_tr_b16 v[60:61], v18 offset:28672
    ds_read_b64_tr_b16 v[62:63], v18 offset:29184
    s_lshl4_add_u32 s35, s49, 0
    buffer_load_dwordx4 v[168:171], v12, s[20:23], s35 offen sc1
    v_exp_f32 v102, v102
    v_mfma_f32_32x32x16_bf16 v[112:127], v[40:43], v[200:203], v[112:127]
    s_waitcnt vmcnt(9)
    s_atomic_add s67, s[20:21], s61 offset:132096
    ds_read_b64_tr_b16 v[32:33], v18 offset:32768
    ds_read_b64_tr_b16 v[34:35], v18 offset:33280
    v_exp_f32 v103, v103
    v_fma_f32 v100, v100, v30, v30
    v_mfma_f32_32x32x16_bf16 v[112:127], v[44:47], v[204:207], v[112:127]
    ds_read_b64_tr_b16 v[36:37], v18 offset:36864
    ds_read_b64_tr_b16 v[38:39], v18 offset:37376
    buffer_load_dwordx4 v[172:175], v13, s[20:23], s35 offen sc1
    v_fma_f32 v101, v101, v30, v30
    v_fma_f32 v102, v102, v30, v30
    v_fma_f32 v103, v103, v30, v30
    s_waitcnt lgkmcnt(4)
    v_mfma_f32_32x32x16_bf16 v[112:127], v[48:51], v[208:211], v[112:127]
    ds_read_b64_tr_b16 v[40:41], v18 offset:40960
    s_nop 0
    ds_read_b64_tr_b16 v[42:43], v18 offset:41472
    v_rcp_f32 v100, v100
    v_rcp_f32 v101, v101
    v_mfma_f32_32x32x16_bf16 v[112:127], v[52:55], v[212:215], v[112:127]
    ds_read_b64_tr_b16 v[44:45], v18 offset:45056
    ds_read_b64_tr_b16 v[46:47], v18 offset:45568
    s_lshl4_add_u32 s35, s50, 0
    buffer_load_dwordx4 v[176:179], v12, s[20:23], s35 offen sc1
    v_rcp_f32 v102, v102
    v_mfma_f32_32x32x16_bf16 v[112:127], v[56:59], v[216:219], v[112:127]
    ds_read_b64_tr_b16 v[48:49], v19 offset:0
    ds_read_b64_tr_b16 v[50:51], v19 offset:512
    v_rcp_f32 v103, v103
    v_mul_f32 v100, v100, v108
    v_mul_f32 v101, v101, v109
    v_mul_f32 v102, v102, v110
    v_mfma_f32_32x32x16_bf16 v[112:127], v[60:63], v[220:223], v[112:127]
    ds_read_b64_tr_b16 v[52:53], v19 offset:4096
    ds_read_b64_tr_b16 v[54:55], v19 offset:4608
    buffer_load_dwordx4 v[180:183], v13, s[20:23], s35 offen sc1
    v_mul_f32 v103, v103, v111
    v_cvt_pk_bf16_f32 v138, v100, v101
    v_cvt_pk_bf16_f32 v139, v102, v103
    s_waitcnt lgkmcnt(4)
    v_mfma_f32_32x32x16_bf16 v[112:127], v[32:35], v[224:227], v[112:127]
    ds_read_b64_tr_b16 v[56:57], v19 offset:8192
    ds_read_b64_tr_b16 v[58:59], v19 offset:8704
    v_mfma_f32_32x32x16_bf16 v[112:127], v[36:39], v[228:231], v[112:127]
    ds_read_b64_tr_b16 v[60:61], v19 offset:12288
    ds_read_b64_tr_b16 v[62:63], v19 offset:12800
    s_lshl4_add_u32 s35, s51, 0
    buffer_load_dwordx4 v[184:187], v12, s[20:23], s35 offen sc1
    v_mfma_f32_32x32x16_bf16 v[112:127], v[40:43], v[232:235], v[112:127]
    v_mfma_f32_32x32x16_bf16 v[112:127], v[44:47], v[236:239], v[112:127]
    buffer_load_dwordx4 v[188:191], v13, s[20:23], s35 offen sc1
    s_waitcnt lgkmcnt(0)
    v_mfma_f32_32x32x16_bf16 v[112:127], v[48:51], v[240:243], v[112:127]
    v_mfma_f32_32x32x16_bf16 v[112:127], v[52:55], v[244:247], v[112:127]
    s_lshl4_add_u32 s35, s52, 0
    buffer_load_dwordx4 v[192:195], v12, s[20:23], s35 offen sc1
    v_mfma_f32_32x32x16_bf16 v[112:127], v[56:59], v[248:251], v[112:127]
    v_mfma_f32_32x32x16_bf16 v[112:127], v[60:63], v[252:255], v[112:127]
    s_nop 0
    buffer_load_dwordx4 v[196:199], v13, s[20:23], s35 offen sc1
    s_waitcnt vmcnt(13)
    v_mfma_f32_32x32x16_bf16 v[64:79], a[0:3], v[144:147], 0
    s_waitcnt vmcnt(12)
    v_mfma_f32_32x32x16_bf16 v[80:95], a[0:3], v[148:151], 0
    s_lshl4_add_u32 s35, s46, 28672
    buffer_load_dwordx4 v[200:203], v12, s[20:23], s35 offen sc1
    s_sub_u32 s44, s69, s30
    s_cmp_eq_u32 s44, 16
    s_cbranch_scc0 L_slow4
L_ok4:
    s_nop 0
    v_mfma_f32_32x32x16_bf16 v[32:47], a[4:7], v[144:147], 0
    s_mov_b32 s68, 0
    s_atomic_add s68, s[20:21], s62 offset:132096 glc
    v_mul_f32 v112, v31, v112
    v_mul_f32 v113, v31, v113
    v_mul_f32 v114, v31, v114
    v_mul_f32 v115, v31, v115
    v_exp_f32 v112, v112
    v_mfma_f32_32x32x16_bf16 v[48:63], a[4:7], v[148:151], 0
    buffer_load_dwordx4 v[204:207], v13, s[20:23], s35 offen sc1
    v_exp_f32 v113, v113
    v_exp_f32 v114, v114
    v_exp_f32 v115, v115
    v_fma_f32 v112, v112, v30, v30
    s_waitcnt vmcnt(13)
    v_mfma_f32_32x32x16_bf16 v[64:79], a[8:11], v[152:155], v[64:79]
    v_fma_f32 v113, v113, v30, v30
    v_fma_f32 v114, v114, v30, v30
    v_fma_f32 v115, v115, v30, v30
    v_rcp_f32 v112, v112
    v_rcp_f32_e64 v113, v113
    s_waitcnt vmcnt(12)
    v_mfma_f32_32x32x16_bf16 v[80:95], a[8:11], v[156:159], v[80:95]
    s_lshl4_add_u32 s35, s47, 28672
    buffer_load_dwordx4 v[208:211], v12, s[20:23], s35 offen sc1
    v_rcp_f32 v114, v114
    v_rcp_f32 v115, v115
    v_mul_f32 v112, v112, v120
    v_mul_f32 v113, v113, v121
    v_mfma_f32_32x32x16_bf16 v[32:47], a[12:15], v[152:155], v[32:47]
    v_mul_f32 v114, v114, v122
    v_mul_f32 v115, v115, v123
    v_cvt_pk_bf16_f32 v140, v112, v113
    v_cvt_pk_bf16_f32 v141, v114, v115
    v_mul_f32 v116, v31, v116
    v_mul_f32 v117, v31, v117
    v_mul_f32 v118, v31, v118
    v_mul_f32 v119, v31, v119
    v_mfma_f32_32x32x16_bf16 v[48:63], a[12:15], v[156:159], v[48:63]
    buffer_load_dwordx4 v[212:215], v13, s[20:23], s35 offen sc1
    v_exp_f32 v116, v116
    v_exp_f32 v117, v117
    v_exp_f32 v118, v118
    s_waitcnt vmcnt(13)
    v_mfma_f32_32x32x16_bf16 v[64:79], a[16:19], v[160:163], v[64:79]
    v_exp_f32_e64 v119, v119
    v_fma_f32 v116, v116, v30, v30
    v_fma_f32 v117, v117, v30, v30
    v_fma_f32 v118, v118, v30, v30
    v_fma_f32 v119, v119, v30, v30
    v_rcp_f32 v116, v116
    s_waitcnt vmcnt(12)
    v_mfma_f32_32x32x16_bf16 v[80:95], a[16:19], v[164:167], v[80:95]
    s_lshl4_add_u32 s35, s48, 28672
    buffer_load_dwordx4 v[216:219], v12, s[20:23], s35 offen sc1
    v_rcp_f32 v117, v117
    v_rcp_f32 v118, v118
    v_rcp_f32 v119, v119
    v_mfma_f32_32x32x16_bf16 v[32:47], a[20:23], v[160:163], v[32:47]
    v_mul_f32 v116, v116, v124
    v_mul_f32 v117, v117, v125
    v_mul_f32 v118, v118, v126
    v_mul_f32_e64 v119, v119, v127
    v_cvt_pk_bf16_f32 v142, v116, v117
    v_cvt_pk_bf16_f32 v143, v118, v119
    s_add_u32 s37, s60, 86016
    v_mfma_f32_32x32x16_bf16 v[48:63], a[20:23], v[164:167], v[48:63]
    buffer_load_dwordx4 v[220:223], v13, s[20:23], s35 offen sc1
    buffer_store_dwordx4 v[136:139], v24, s[20:23], s37 offen offset:0 sc1
    s_waitcnt vmcnt(14)
    v_mfma_f32_32x32x16_bf16 v[64:79], a[24:27], v[168:171], v[64:79]
    buffer_store_dwordx4 v[140:143], v24, s[20:23], s37 offen offset:1024 sc1
    v_bfe_u32 v2, v0, 2, 1
    s_nop 0
    v_bfe_u32 v3, v0, 3, 2
    v_and_b32 v4, 3, v0
    v_lshl_add_u32 v4, v3, 2, v4
    s_waitcnt vmcnt(14)
    v_mfma_f32_32x32x16_bf16 v[80:95], a[24:27], v[172:175], v[80:95]
    s_lshl4_add_u32 s35, s49, 28672
    buffer_load_dwordx4 v[224:227], v12, s[20:23], s35 offen sc1
    v_lshl_add_u32 v30, v2, 4, v4
    v_mul_u32_u24 v31, 28672, v28
    v_lshrrev_b32 v14, 5, v0
    v_lshl_add_u32 v31, v14, 5, v31
    s_mul_i32 s53, s1, 896
    s_lshl1_add_u32 s54, s0, s33
    v_mfma_f32_32x32x16_bf16 v[32:47], a[28:31], v[168:171], v[32:47]
    s_lshl_b32 s54, s54, 5
    v_add_u32 v4, s54, v30
    s_lshl1_add_u32 s53, s54, s53
    v_add_u32 v31, s53, v31
    v_bfe_u32 v6, v0, 1, 4
    v_lshlrev_b32_e64 v2, 1, v14
    v_bfe_u32 v3, v0, 2, 2
    v_xor_b32 v2, v2, v3
    v_mfma_f32_32x32x16_bf16 v[48:63], a[28:31], v[172:175], v[48:63]
    buffer_load_dwordx4 v[228:231], v13, s[20:23], s35 offen sc1
    v_and_b32 v3, 1, v0
    v_lshl_add_u32 v2, v2, 1, v3
    v_lshlrev_b32_e64 v2, 4, v2
    v_lshl_add_u32 v2, v6, 7, v2
    s_mul_i32 s53, s32, 49152
    s_add_u32 s53, s53, 81920
    v_add_u32 v20, s53, v2
    s_waitcnt vmcnt(15)
    v_mfma_f32_32x32x16_bf16 v[64:79], a[32:35], v[176:179], v[64:79]
    v_xor_b32 v21, 32, v20
    s_lshl_b32 s53, s32, 14
    s_sub_u32 s53, 114688, s53
    v_add_u32 v22, s53, v2
    v_xor_b32 v23, 32, v22
    s_lshl_b32 s53, s3, 14
    v_add_u32 v15, s53, v24
    v_xor_b32 v16, 0x4000, v15
    s_waitcnt vmcnt(14)
    v_mfma_f32_32x32x16_bf16 v[80:95], a[32:35], v[180:183], v[80:95]
    s_lshl4_add_u32 s35, s50, 28672
    buffer_load_dwordx4 v[232:235], v12, s[20:23], s35 offen sc1
    v_xor_b32 v17, 0x8000, v15
    v_xor_b32 v18, 0xc000, v15
    v_lshlrev_b32 v7, 15, v4
    v_and_b32 v7, 0x8000, v7
    v_or_b32 v7, 0x3f80, v7
    v_cvt_f32_u32 v4, v4
    v_mfma_f32_32x32x16_bf16 v[32:47], a[36:39], v[176:179], v[32:47]
    v_mul_f32 v4, 0x3b124925, v4
    v_cvt_f32_u32 v5, s32
    v_mul_f32 v5, 0x3e800000, v5
    v_lshlrev_b32 v2, 4, v14
    v_cvt_f32_u32 v2, v2
    v_mul_f32 v2, v2, v4
    v_fract_f32 v2, v2
    v_add_f32_e64 v5, v5, v2
    v_mfma_f32_32x32x16_bf16 v[48:63], a[36:39], v[180:183], v[48:63]
    buffer_load_dwordx4 v[236:239], v13, s[20:23], s35 offen sc1
    v_mul_f32 v6, 0x42000000, v4
    v_fract_f32 v6, v6
    v_add_f32 v2, v4, v4
    v_cos_f32 v3, v6
    v_cos_f32 v2, v2
    s_waitcnt vmcnt(15)
    v_mfma_f32_32x32x16_bf16 v[64:79], a[40:43], v[184:187], v[64:79]
    v_add_f32 v6, v6, v5
    v_add_f32 v3, v3, v3
    v_add_f32 v2, v2, v2
    v_add_f32_e64 v145, v4, v5
    v_fma_f32 v146, v4, 2.0, v5
    v_fmamk_f32 v147, v4, 0x40400000, v5
    v_cos_f32 v144, v5
    s_waitcnt vmcnt(14)
    v_mfma_f32_32x32x16_bf16 v[80:95], a[40:43], v[188:191], v[80:95]
    s_lshl4_add_u32 s35, s51, 28672
    buffer_load_dwordx4 v[240:243], v12, s[20:23], s35 offen sc1
    v_cos_f32 v145, v145
    v_cos_f32 v146, v146
    v_cos_f32_e64 v147, v147
    v_mfma_f32_32x32x16_bf16 v[32:47], a[44:47], v[184:187], v[32:47]
    v_add_f32 v161, v4, v6
    v_fma_f32 v162, v4, 2.0, v6
    v_fmamk_f32 v163, v4, 0x40400000, v6
    v_cos_f32 v160, v6
    v_cos_f32 v161, v161
    v_mfma_f32_32x32x16_bf16 v[48:63], a[44:47], v[188:191], v[48:63]
    buffer_load_dwordx4 v[244:247], v13, s[20:23], s35 offen sc1
    v_cos_f32 v162, v162
    v_cos_f32_e64 v163, v163
    v_fma_f32 v148, v146, v2, -v144
    v_fma_f32 v149, v147, v2, -v145
    v_fma_f32 v164, v162, v2, -v160
    s_sub_u32 s44, s68, s30
    s_cmp_eq_u32 s44, 14
    s_cbranch_scc0 L_slow5
L_ok5:
    s_waitcnt vmcnt(15)
    v_mfma_f32_32x32x16_bf16 v[64:79], a[48:51], v[192:195], v[64:79]
    v_fma_f32 v165, v163, v2, -v161
    v_fma_f32 v150, v148, v2, -v146
    v_fma_f32 v151, v149, v2, -v147
    v_fma_f32 v166, v164, v2, -v162
    v_fma_f32 v167, v165, v2, -v163
    v_fma_f32 v152, v150, v2, -v148
    v_fma_f32 v153, v151, v2, -v149
    v_fma_f32 v168, v166, v2, -v164
    s_waitcnt vmcnt(14)
    v_mfma_f32_32x32x16_bf16 v[80:95], a[48:51], v[196:199], v[80:95]
    s_nop 0
    s_lshl4_add_u32 s35, s52, 28672
    buffer_load_dwordx4 v[248:251], v12, s[20:23], s35 offen sc1
    v_fma_f32 v169, v167, v2, -v165
    v_fma_f32 v154, v152, v2, -v150
    v_fma_f32 v155, v153, v2, -v151
    v_fma_f32 v170, v168, v2, -v166
    v_fma_f32 v171, v169, v2, -v167
    v_fma_f32 v156, v154, v2, -v152
    v_mfma_f32_32x32x16_bf16 v[32:47], a[52:55], v[192:195], v[32:47]
    v_fma_f32 v157, v155, v2, -v153
    v_fma_f32 v172, v170, v2, -v168
    v_fma_f32 v173, v171, v2, -v169
    v_fma_f32 v158, v156, v2, -v154
    v_fma_f32 v159, v157, v2, -v155
    v_fma_f32 v174, v172, v2, -v170
    v_fma_f32 v175, v173, v2, -v171
    v_cvt_pk_bf16_f32 v176, v144, v146
    v_mfma_f32_32x32x16_bf16 v[48:63], a[52:55], v[196:199], v[48:63]
    buffer_load_dwordx4 v[252:255], v13, s[20:23], s35 offen sc1
    v_cvt_pk_bf16_f32 v177, v148, v150
    v_cvt_pk_bf16_f32 v178, v152, v154
    v_cvt_pk_bf16_f32 v179, v156, v158
    v_cvt_pk_bf16_f32 v180, v145, v147
    v_cvt_pk_bf16_f32 v181, v149, v151
    v_cvt_pk_bf16_f32 v182, v153, v155
    v_cvt_pk_bf16_f32 v183, v157, v159
    s_waitcnt vmcnt(15)
    v_mfma_f32_32x32x16_bf16 v[64:79], a[56:59], v[200:203], v[64:79]
    s_nop 0
    v_cvt_pk_bf16_f32 v184, v160, v162
    v_cvt_pk_bf16_f32 v185, v164, v166
    v_cvt_pk_bf16_f32 v186, v168, v170
    v_cvt_pk_bf16_f32 v187, v172, v174
    v_cvt_pk_bf16_f32 v188, v161, v163
    v_cvt_pk_bf16_f32 v189, v165, v167
    s_waitcnt vmcnt(14)
    v_mfma_f32_32x32x16_bf16 v[80:95], a[56:59], v[204:207], v[80:95]
    s_nop 0
    s_lshl4_add_u32 s35, s46, 57344
    buffer_load_dwordx4 a[0:3], v12, s[20:23], s35 offen sc1
    v_cvt_pk_bf16_f32 v190, v169, v171
    v_cvt_pk_bf16_f32 v191, v173, v175
    v_fma_f32 v144, v160, v3, -v144
    v_fma_f32 v145, v161, v3, -v145
    v_mfma_f32_32x32x16_bf16 v[32:47], a[60:63], v[200:203], v[32:47]
    s_waitcnt vmcnt(9)
    s_nop 0
    s_atomic_add s67, s[20:21], s61 offset:132608
    v_fma_f32 v146, v162, v3, -v146
    v_fma_f32 v147, v163, v3, -v147
    v_fma_f32 v148, v164, v3, -v148
    v_fma_f32 v149, v165, v3, -v149
    v_mfma_f32_32x32x16_bf16 v[48:63], a[60:63], v[204:207], v[48:63]
    buffer_load_dwordx4 a[4:7], v13, s[20:23], s35 offen sc1
    v_fma_f32 v150, v166, v3, -v150
    v_fma_f32 v151, v167, v3, -v151
    v_fma_f32 v152, v168, v3, -v152
    v_fma_f32 v153, v169, v3, -v153
    v_fma_f32 v154, v170, v3, -v154
    v_mfma_f32_32x32x16_bf16 v[64:79], a[64:67], v[208:211], v[64:79]
    v_fma_f32 v155, v171, v3, -v155
    v_fma_f32 v156, v172, v3, -v156
    v_fma_f32 v157, v173, v3, -v157
    v_fma_f32 v158, v174, v3, -v158
    v_fma_f32 v159, v175, v3, -v159
    v_cvt_pk_bf16_f32 v192, v144, v146
    v_mfma_f32_32x32x16_bf16 v[80:95], a[64:67], v[212:215], v[80:95]
    s_lshl4_add_u32 s35, s47, 57344
    buffer_load_dwordx4 a[8:11], v12, s[20:23], s35 offen sc1
    v_cvt_pk_bf16_f32 v193, v148, v150
    v_cvt_pk_bf16_f32 v194, v152, v154
    v_cvt_pk_bf16_f32 v195, v156, v158
    v_cvt_pk_bf16_f32 v196, v145, v147
    v_mfma_f32_32x32x16_bf16 v[32:47], a[68:71], v[208:211], v[32:47]
    v_cvt_pk_bf16_f32 v197, v149, v151
    v_cvt_pk_bf16_f32 v198, v153, v155
    v_cvt_pk_bf16_f32 v199, v157, v159
    v_fma_f32 v160, v144, v3, -v160
    v_fma_f32 v161, v145, v3, -v161
    v_fma_f32 v162, v146, v3, -v162
    v_mfma_f32_32x32x16_bf16 v[48:63], a[68:71], v[212:215], v[48:63]
    buffer_load_dwordx4 a[12:15], v13, s[20:23], s35 offen sc1
    v_fma_f32 v163, v147, v3, -v163
    v_fma_f32 v164, v148, v3, -v164
    v_fma_f32 v165, v149, v3, -v165
    v_fma_f32 v166, v150, v3, -v166
    v_fma_f32 v167, v151, v3, -v167
    v_mfma_f32_32x32x16_bf16 v[64:79], a[72:75], v[216:219], v[64:79]
    v_fma_f32 v168, v152, v3, -v168
    v_fma_f32 v169, v153, v3, -v169
    v_fma_f32 v170, v154, v3, -v170
    v_fma_f32 v171, v155, v3, -v171
    v_fma_f32 v172, v156, v3, -v172
    v_fma_f32 v173, v157, v3, -v173
    v_mfma_f32_32x32x16_bf16 v[80:95], a[72:75], v[220:223], v[80:95]
    s_lshl4_add_u32 s35, s48, 57344
    buffer_load_dwordx4 a[16:19], v12, s[20:23], s35 offen sc1
    v_fma_f32 v174, v158, v3, -v174
    v_fma_f32 v175, v159, v3, -v175
    v_cvt_pk_bf16_f32 v200, v160, v162
    v_cvt_pk_bf16_f32 v201, v164, v166
    v_mfma_f32_32x32x16_bf16 v[32:47], a[76:79], v[216:219], v[32:47]
    s_mov_b32 s69, 0
    s_nop 0
    s_atomic_add s69, s[20:21], s18 offset:133888 glc
    v_cvt_pk_bf16_f32 v202, v168, v170
    v_cvt_pk_bf16_f32 v203, v172, v174
    v_cvt_pk_bf16_f32 v204, v161, v163
    v_cvt_pk_bf16_f32 v205, v165, v167
    v_mfma_f32_32x32x16_bf16 v[48:63], a[76:79], v[220:223], v[48:63]
    buffer_load_dwordx4 a[20:23], v13, s[20:23], s35 offen sc1
    v_cvt_pk_bf16_f32 v206, v169, v171
    v_cvt_pk_bf16_f32 v207, v173, v175
    v_fma_f32 v144, v160, v3, -v144
    v_fma_f32 v145, v161, v3, -v145
    v_fma_f32 v146, v162, v3, -v146
    s_waitcnt vmcnt(13)
    v_mfma_f32_32x32x16_bf16 v[64:79], a[80:83], v[224:227], v[64:79]
    v_fma_f32 v147, v163, v3, -v147
    v_fma_f32 v148, v164, v3, -v148
    s_nop 0
    v_fma_f32 v149, v165, v3, -v149
    v_fma_f32 v150, v166, v3, -v150
    v_fma_f32 v151, v167, v3, -v151
    v_fma_f32 v152, v168, v3, -v152
    s_waitcnt vmcnt(12)
    v_mfma_f32_32x32x16_bf16 v[80:95], a[80:83], v[228:231], v[80:95]
    s_lshl4_add_u32 s35, s49, 57344
    buffer_load_dwordx4 a[24:27], v12, s[20:23], s35 offen sc1
    s_nop 0
    v_fma_f32 v153, v169, v3, -v153
    v_fma_f32 v154, v170, v3, -v154
    v_fma_f32 v155, v171, v3, -v155
    v_fma_f32 v156, v172, v3, -v156
    v_mfma_f32_32x32x16_bf16 v[32:47], a[84:87], v[224:227], v[32:47]
    v_fma_f32 v157, v173, v3, -v157
    v_fma_f32 v158, v174, v3, -v158
    v_fma_f32 v159, v175, v3, -v159
    v_cvt_pk_bf16_f32 v208, v144, v146
    v_cvt_pk_bf16_f32 v209, v148, v150
    v_cvt_pk_bf16_f32 v210, v152, v154
    v_mfma_f32_32x32x16_bf16 v[48:63], a[84:87], v[228:231], v[48:63]
    buffer_load_dwordx4 a[28:31], v13, s[20:23], s35 offen sc1
    v_cvt_pk_bf16_f32 v211, v156, v158
    v_cvt_pk_bf16_f32 v212, v145, v147
    v_cvt_pk_bf16_f32 v213, v149, v151
    v_cvt_pk_bf16_f32 v214, v153, v155
    v_cvt_pk_bf16_f32 v215, v157, v159
    s_waitcnt vmcnt(13)
    v_mfma_f32_32x32x16_bf16 v[64:79], a[88:91], v[232:235], v[64:79]
    s_nop 0
    v_fma_f32 v160, v144, v3, -v160
    v_fma_f32 v161, v145, v3, -v161
    v_fma_f32 v162, v146, v3, -v162
    v_fma_f32 v163, v147, v3, -v163
    v_fma_f32 v164, v148, v3, -v164
    v_fma_f32 v165, v149, v3, -v165
    s_waitcnt vmcnt(12)
    v_mfma_f32_32x32x16_bf16 v[80:95], a[88:91], v[236:239], v[80:95]
    s_nop 0
    s_lshl4_add_u32 s35, s50, 57344
    buffer_load_dwordx4 a[32:35], v12, s[20:23], s35 offen sc1
    v_fma_f32 v166, v150, v3, -v166
    v_fma_f32 v167, v151, v3, -v167
    v_fma_f32 v168, v152, v3, -v168
    v_fma_f32 v169, v153, v3, -v169
    v_mfma_f32_32x32x16_bf16 v[32:47], a[92:95], v[232:235], v[32:47]
    v_fma_f32 v170, v154, v3, -v170
    v_fma_f32 v171, v155, v3, -v171
    v_fma_f32 v172, v156, v3, -v172
    v_fma_f32 v173, v157, v3, -v173
    v_fma_f32 v174, v158, v3, -v174
    v_fma_f32 v175, v159, v3, -v175
    v_mfma_f32_32x32x16_bf16 v[48:63], a[92:95], v[236:239], v[48:63]
    buffer_load_dwordx4 a[36:39], v13, s[20:23], s35 offen sc1
    v_cvt_pk_bf16_f32 v216, v160, v162
    v_cvt_pk_bf16_f32 v217, v164, v166
    v_cvt_pk_bf16_f32 v218, v168, v170
    v_cvt_pk_bf16_f32 v219, v172, v174
    v_cvt_pk_bf16_f32 v220, v161, v163
    s_waitcnt vmcnt(13)
    v_mfma_f32_32x32x16_bf16 v[64:79], a[96:99], v[240:243], v[64:79]
    v_cvt_pk_bf16_f32 v221, v165, v167
    v_cvt_pk_bf16_f32 v222, v169, v171
    s_nop 0
    v_cvt_pk_bf16_f32 v223, v173, v175
    v_fma_f32 v144, v160, v3, -v144
    v_fma_f32 v145, v161, v3, -v145
    v_fma_f32 v146, v162, v3, -v146
    s_waitcnt vmcnt(12)
    v_mfma_f32_32x32x16_bf16 v[80:95], a[96:99], v[244:247], v[80:95]
    s_lshl4_add_u32 s35, s51, 57344
    buffer_load_dwordx4 a[40:43], v12, s[20:23], s35 offen sc1
    s_nop 0
    v_fma_f32 v147, v163, v3, -v147
L_padg4:
    s_cbranch_execz L_padg8
    v_fma_f32 v148, v164, v3, -v148
    v_fma_f32 v149, v165, v3, -v149
    s_nop 0
    v_fma_f32 v150, v166, v3, -v150
    v_mfma_f32_32x32x16_bf16 v[32:47], a[100:103], v[240:243], v[32:47]
    v_fma_f32 v151, v167, v3, -v151
    v_fma_f32 v152, v168, v3, -v152
    v_fma_f32 v153, v169, v3, -v153
    v_fma_f32 v154, v170, v3, -v154
    v_fma_f32 v155, v171, v3, -v155
    v_fma_f32 v156, v172, v3, -v156
    v_mfma_f32_32x32x16_bf16 v[48:63], a[100:103], v[244:247], v[48:63]
    buffer_load_dwordx4 a[44:47], v13, s[20:23], s35 offen sc1
    v_fma_f32 v157, v173, v3, -v157
    v_fma_f32 v158, v174, v3, -v158
    v_fma_f32 v159, v175, v3, -v159
    v_cvt_pk_bf16_f32 v224, v144, v146
    v_cvt_pk_bf16_f32 v225, v148, v150
    s_sub_u32 s44, s69, s30
    s_cmp_eq_u32 s44, 16
    s_cbranch_scc0 L_slow6
L_ok6:
    s_waitcnt vmcnt(13)
    v_mfma_f32_32x32x16_bf16 v[64:79], a[104:107], v[248:251], v[64:79]
    v_cvt_pk_bf16_f32 v226, v152, v154
    v_cvt_pk_bf16_f32 v227, v156, v158
    v_cvt_pk_bf16_f32 v228, v145, v147
    v_cvt_pk_bf16_f32 v229, v149, v151
    v_cvt_pk_bf16_f32 v230, v153, v155
    v_cvt_pk_bf16_f32 v231, v157, v159
    s_waitcnt vmcnt(12)
    v_mfma_f32_32x32x16_bf16 v[80:95], a[104:107], v[252:255], v[80:95]
    s_lshl4_add_u32 s35, s52, 57344
    buffer_load_dwordx4 a[48:51], v12, s[20:23], s35 offen sc1
    v_xor_b32 v14, 1, v14
    v_and_b32_e64 v14, s32, v14
    v_mul_u32_u24 v14, 0xffff, v14
    v_bfi_b32 v176, v14, v7, v176
    v_mfma_f32_32x32x16_bf16 v[32:47], a[108:111], v[248:251], v[32:47]
    v_mfma_f32_32x32x16_bf16 v[48:63], a[108:111], v[252:255], v[48:63]
    buffer_load_dwordx4 a[52:55], v13, s[20:23], s35 offen sc1
    s_waitcnt vmcnt(13)
    v_mfma_f32_32x32x16_bf16 v[64:79], a[112:115], a[0:3], v[64:79]
    s_waitcnt vmcnt(12)
    v_mfma_f32_32x32x16_bf16 v[80:95], a[112:115], a[4:7], v[80:95]
    s_add_u32 m0, s17, 0
    s_add_u32 s35, s16, 0
    buffer_load_dwordx4 v24, s[20:23], s35 offen sc1 lds
    v_mfma_f32_32x32x16_bf16 v[32:47], a[116:119], a[0:3], v[32:47]
    s_mov_b32 s68, 0
    s_atomic_add s68, s[20:21], s62 offset:132608 glc
    v_mfma_f32_32x32x16_bf16 v[48:63], a[116:119], a[4:7], v[48:63]
    buffer_load_dwordx4 v24, s[20:23], s35 offen offset:1024 sc1 lds
    s_waitcnt vmcnt(13)
    v_mfma_f32_32x32x16_bf16 v[64:79], a[120:123], a[8:11], v[64:79]
    s_waitcnt vmcnt(12)
    v_mfma_f32_32x32x16_bf16 v[80:95], a[120:123], a[12:15], v[80:95]
    s_add_u32 m0, s17, 2048
    s_nop 0
    s_add_u32 s35, s16, 2048
    buffer_load_dwordx4 v24, s[20:23], s35 offen sc1 lds
    v_mfma_f32_32x32x16_bf16 v[32:47], a[124:127], a[8:11], v[32:47]
    v_mfma_f32_32x32x16_bf16 v[48:63], a[124:127], a[12:15], v[48:63]
    buffer_load_dwordx4 v24, s[20:23], s35 offen offset:1024 sc1 lds
    s_waitcnt vmcnt(13)
    v_mfma_f32_32x32x16_bf16 v[64:79], a[128:131], a[16:19], v[64:79]
    s_waitcnt vmcnt(12)
    v_mfma_f32_32x32x16_bf16 v[80:95], a[128:131], a[20:23], v[80:95]
    s_add_u32 m0, s17, 4096
    s_add_u32 s35, s16, 4096
    buffer_load_dwordx4 v24, s[20:23], s35 offen sc1 lds
    v_mfma_f32_32x32x16_bf16 v[32:47], a[132:135], a[16:19], v[32:47]
    v_mfma_f32_32x32x16_bf16 v[48:63], a[132:135], a[20:23], v[48:63]
    buffer_load_dwordx4 v24, s[20:23], s35 offen offset:1024 sc1 lds
    s_waitcnt vmcnt(13)
    v_mfma_f32_32x32x16_bf16 v[64:79], a[136:139], a[24:27], v[64:79]
    s_waitcnt vmcnt(12)
    v_mfma_f32_32x32x16_bf16 v[80:95], a[136:139], a[28:31], v[80:95]
    s_add_u32 m0, s17, 6144
    s_add_u32 s35, s16, 6144
    buffer_load_dwordx4 v24, s[20:23], s35 offen sc1 lds
    v_mfma_f32_32x32x16_bf16 v[32:47], a[140:143], a[24:27], v[32:47]
    v_mfma_f32_32x32x16_bf16 v[48:63], a[140:143], a[28:31], v[48:63]
    buffer_load_dwordx4 v24, s[20:23], s35 offen offset:1024 sc1 lds
    s_waitcnt vmcnt(13)
    v_mfma_f32_32x32x16_bf16 v[64:79], a[144:147], a[32:35], v[64:79]
    s_waitcnt vmcnt(12)
    v_mfma_f32_32x32x16_bf16 v[80:95], a[144:147], a[36:39], v[80:95]
    s_add_u32 m0, s17, 8192
    s_add_u32 s35, s16, 8192
    buffer_load_dwordx4 v24, s[20:23], s35 offen sc1 lds
    v_mfma_f32_32x32x16_bf16 v[32:47], a[148:151], a[32:35], v[32:47]
    v_mfma_f32_32x32x16_bf16 v[48:63], a[148:151], a[36:39], v[48:63]
    buffer_load_dwordx4 v24, s[20:23], s35 offen offset:1024 sc1 lds
    s_sub_u32 s44, s68, s30
    s_cmp_eq_u32 s44, 14
    s_cbranch_scc0 L_slow7
L_ok7:
    s_waitcnt vmcnt(13)
    v_mfma_f32_32x32x16_bf16 v[64:79], a[152:155], a[40:43], v[64:79]
    s_waitcnt vmcnt(12)
    s_nop 0
    v_mfma_f32_32x32x16_bf16 v[80:95], a[152:155], a[44:47], v[80:95]
    s_add_u32 m0, s17, 10240
    s_add_u32 s35, s16, 10240
    buffer_load_dwordx4 v24, s[20:23], s35 offen sc1 lds
    v_mfma_f32_32x32x16_bf16 v[32:47], a[156:159], a[40:43], v[32:47]
    s_waitcnt vmcnt(3)
    s_barrier
    ds_read_b128 v[144:147], v20 offset:0
    v_mfma_f32_32x32x16_bf16 v[48:63], a[156:159], a[44:47], v[48:63]
    ds_read_b128 v[148:151], v22 offset:0
    buffer_load_dwordx4 v24, s[20:23], s35 offen offset:1024 sc1 lds
    v_mfma_f32_32x32x16_bf16 v[64:79], a[160:163], a[48:51], v[64:79]
    ds_read_b128 v[152:155], v21 offset:0
    v_mfma_f32_32x32x16_bf16 v[80:95], a[160:163], a[52:55], v[80:95]
    ds_read_b128 v[156:159], v23 offset:0
    s_add_u32 m0, s17, 12288
    s_add_u32 s35, s16, 12288
    buffer_load_dwordx4 v24, s[20:23], s35 offen sc1 lds
    v_mfma_f32_32x32x16_bf16 v[32:47], a[164:167], a[48:51], v[32:47]
    ds_read_b128 v[160:163], v20 offset:2048
    v_mfma_f32_32x32x16_bf16 v[48:63], a[164:167], a[52:55], v[48:63]
    ds_read_b128 v[164:167], v22 offset:2048
    buffer_load_dwordx4 v24, s[20:23], s35 offen offset:1024 sc1 lds
    s_waitcnt lgkmcnt(2)
    v_mfma_f32_32x32x16_bf16 v[96:111], v[144:147], v[176:179], 0
    s_nop 0
    ds_read_b128 v[168:171], v21 offset:2048
    v_mfma_f32_32x32x16_bf16 v[112:127], v[148:151], v[176:179], 0
    ds_read_b128 v[172:175], v23 offset:2048
    s_lshl4_add_u32 s35, s46, 86016
    buffer_load_dwordx4 a[56:59], v12, s[20:23], s35 offen sc1
    v_mfma_f32_32x32x16_bf16 v[96:111], v[152:155], v[180:183], v[96:111]
    ds_read_b128 v[144:147], v20 offset:4096
    v_mfma_f32_32x32x16_bf16 v[112:127], v[156:159], v[180:183], v[112:127]
    ds_read_b128 v[148:151], v22 offset:4096
    buffer_load_dwordx4 a[60:63], v13, s[20:23], s35 offen sc1
    s_waitcnt lgkmcnt(2)
    v_mfma_f32_32x32x16_bf16 v[96:111], v[160:163], v[184:187], v[96:111]
    s_nop 0
    ds_read_b128 v[152:155], v21 offset:4096
    v_mfma_f32_32x32x16_bf16 v[112:127], v[164:167], v[184:187], v[112:127]
    ds_read_b128 v[156:159], v23 offset:4096
    s_lshl4_add_u32 s35, s47, 86016
    buffer_load_dwordx4 a[64:67], v12, s[20:23], s35 offen sc1
    v_mfma_f32_32x32x16_bf16 v[96:111], v[168:171], v[188:191], v[96:111]
    ds_read_b128 v[160:163], v20 offset:6144
    v_mfma_f32_32x32x16_bf16 v[112:127], v[172:175], v[188:191], v[112:127]
    ds_read_b128 v[164:167], v22 offset:6144
    buffer_load_dwordx4 a[68:71], v13, s[20:23], s35 offen sc1
    s_waitcnt lgkmcnt(2)
    v_mfma_f32_32x32x16_bf16 v[96:111], v[144:147], v[192:195], v[96:111]
    s_nop 0
    ds_read_b128 v[168:171], v21 offset:6144
    v_mfma_f32_32x32x16_bf16 v[112:127], v[148:151], v[192:195], v[112:127]
    ds_read_b128 v[172:175], v23 offset:6144
    s_lshl4_add_u32 s35, s48, 86016
    buffer_load_dwordx4 a[72:75], v12, s[20:23], s35 offen sc1
    v_mfma_f32_32x32x16_bf16 v[96:111], v[152:155], v[196:199], v[96:111]
    s_waitcnt vmcnt(5)
    s_barrier
    ds_read_b128 v[144:147], v20 offset:8192
    v_mfma_f32_32x32x16_bf16 v[112:127], v[156:159], v[196:199], v[112:127]
    ds_read_b128 v[148:151], v22 offset:8192
    buffer_load_dwordx4 a[76:79], v13, s[20:23], s35 offen sc1
    s_waitcnt lgkmcnt(2)
    s_nop 0
    v_mfma_f32_32x32x16_bf16 v[96:111], v[160:163], v[200:203], v[96:111]
    ds_read_b128 v[152:155], v21 offset:8192
    v_mfma_f32_32x32x16_bf16 v[112:127], v[164:167], v[200:203], v[112:127]
    ds_read_b128 v[156:159], v23 offset:8192
    s_lshl4_add_u32 s35, s49, 86016
    buffer_load_dwordx4 a[80:83], v12, s[20:23], s35 offen sc1
    v_mfma_f32_32x32x16_bf16 v[96:111], v[168:171], v[204:207], v[96:111]
    ds_read_b128 v[160:163], v20 offset:10240
    v_mfma_f32_32x32x16_bf16 v[112:127], v[172:175], v[204:207], v[112:127]
    ds_read_b128 v[164:167], v22 offset:10240
    buffer_load_dwordx4 a[84:87], v13, s[20:23], s35 offen sc1
    s_waitcnt lgkmcnt(2)
    s_nop 0
    v_mfma_f32_32x32x16_bf16 v[96:111], v[144:147], v[208:211], v[96:111]
    ds_read_b128 v[168:171], v21 offset:10240
    v_mfma_f32_32x32x16_bf16 v[112:127], v[148:151], v[208:211], v[112:127]
    ds_read_b128 v[172:175], v23 offset:10240
    s_lshl4_add_u32 s35, s50, 86016
    buffer_load_dwordx4 a[88:91], v12, s[20:23], s35 offen sc1
    v_mfma_f32_32x32x16_bf16 v[96:111], v[152:155], v[212:215], v[96:111]
    ds_read_b128 v[144:147], v20 offset:12288
    v_mfma_f32_32x32x16_bf16 v[112:127], v[156:159], v[212:215], v[112:127]
    ds_read_b128 v[148:151], v22 offset:12288
    buffer_load_dwordx4 a[92:95], v13, s[20:23], s35 offen sc1
    s_waitcnt lgkmcnt(2)
    s_nop 0
    v_mfma_f32_32x32x16_bf16 v[96:111], v[160:163], v[216:219], v[96:111]
    ds_read_b128 v[152:155], v21 offset:12288
    v_mfma_f32_32x32x16_bf16 v[112:127], v[164:167], v[216:219], v[112:127]
    ds_read_b128 v[156:159], v23 offset:12288
    s_lshl4_add_u32 s35, s51, 86016
    buffer_load_dwordx4 a[96:99], v12, s[20:23], s35 offen sc1
    v_mfma_f32_32x32x16_bf16 v[96:111], v[168:171], v[220:223], v[96:111]
    v_mfma_f32_32x32x16_bf16 v[112:127], v[172:175], v[220:223], v[112:127]
    buffer_load_dwordx4 a[100:103], v13, s[20:23], s35 offen sc1
    s_waitcnt lgkmcnt(0)
    v_mfma_f32_32x32x16_bf16 v[96:111], v[144:147], v[224:227], v[96:111]
    v_mfma_f32_32x32x16_bf16 v[112:127], v[148:151], v[224:227], v[112:127]
    s_nop 0
    s_lshl4_add_u32 s35, s52, 86016
    buffer_load_dwordx4 a[104:107], v12, s[20:23], s35 offen sc1
    v_mfma_f32_32x32x16_bf16 v[96:111], v[152:155], v[228:231], v[96:111]
    v_mfma_f32_32x32x16_bf16 v[112:127], v[156:159], v[228:231], v[112:127]
    buffer_load_dwordx4 a[108:111], v13, s[20:23], s35 offen sc1
    s_waitcnt vmcnt(13)
    v_mfma_f32_32x32x16_bf16 v[64:79], a[168:171], a[56:59], v[64:79]
    s_waitcnt vmcnt(12)
    v_mfma_f32_32x32x16_bf16 v[80:95], a[168:171], a[60:63], v[80:95]
    buffer_load_dwordx4 v[236:239], v31, s[4:7], 0 offen offset:3088
    v_mfma_f32_32x32x16_bf16 v[32:47], a[172:175], a[56:59], v[32:47]
    s_nop 3
    v_cvt_pk_bf16_f32 v128, v96, v97
    s_nop 0
    v_cvt_pk_bf16_f32 v129, v98, v99
    v_cvt_pk_bf16_f32 v130, v100, v101
    v_cvt_pk_bf16_f32 v131, v102, v103
    v_mfma_f32_32x32x16_bf16 v[48:63], a[172:175], a[60:63], v[48:63]
    ds_write_b128 v15, v[128:131] offset:0
    v_cvt_pk_bf16_f32 v132, v104, v105
    s_waitcnt vmcnt(12)
    v_mfma_f32_32x32x16_bf16 v[64:79], a[176:179], a[64:67], v[64:79]
    v_cvt_pk_bf16_f32 v133, v106, v107
    v_cvt_pk_bf16_f32 v134, v108, v109
    v_cvt_pk_bf16_f32 v135, v110, v111
    s_waitcnt vmcnt(11)
    v_mfma_f32_32x32x16_bf16 v[80:95], a[176:179], a[68:71], v[80:95]
    ds_write_b128 v15, v[132:135] offset:1024
    v_cvt_pk_bf16_f32 v136, v112, v113
    v_mfma_f32_32x32x16_bf16 v[32:47], a[180:183], a[64:67], v[32:47]
    v_cvt_pk_bf16_f32 v137, v114, v115
    v_cvt_pk_bf16_f32 v138, v116, v117
    v_cvt_pk_bf16_f32 v139, v118, v119
    v_mfma_f32_32x32x16_bf16 v[48:63], a[180:183], a[68:71], v[48:63]
    ds_write_b128 v15, v[136:139] offset:2048
    v_cvt_pk_bf16_f32 v140, v120, v121
    s_waitcnt vmcnt(10)
    v_mfma_f32_32x32x16_bf16 v[64:79], a[184:187], a[72:75], v[64:79]
    v_cvt_pk_bf16_f32 v141, v122, v123
    v_cvt_pk_bf16_f32 v142, v124, v125
    v_cvt_pk_bf16_f32 v143, v126, v127
    s_waitcnt vmcnt(9)
    v_mfma_f32_32x32x16_bf16 v[80:95], a[184:187], a[76:79], v[80:95]
    ds_write_b128 v15, v[140:143] offset:3072
    v_mfma_f32_32x32x16_bf16 v[32:47], a[188:191], a[72:75], v[32:47]
    v_mfma_f32_32x32x16_bf16 v[48:63], a[188:191], a[76:79], v[48:63]
    buffer_load_dwordx4 v[232:235], v31, s[4:7], 0 offen offset:3072
    s_waitcnt vmcnt(9)
    s_nop 0
    v_mfma_f32_32x32x16_bf16 v[64:79], a[192:195], a[80:83], v[64:79]
    s_waitcnt vmcnt(8)
    v_mfma_f32_32x32x16_bf16 v[80:95], a[192:195], a[84:87], v[80:95]
    s_waitcnt lgkmcnt(0)
    s_barrier
    s_nop 0
    ds_read_b128 v[152:155], v16 offset:2048
    ds_read_b128 v[156:159], v16 offset:3072
    ds_read_b128 v[144:147], v16 offset:0
    ds_read_b128 v[148:151], v16 offset:1024
    v_mfma_f32_32x32x16_bf16 v[32:47], a[196:199], a[80:83], v[32:47]
    v_mfma_f32_32x32x16_bf16 v[48:63], a[196:199], a[84:87], v[48:63]
    s_waitcnt vmcnt(6)
    v_mfma_f32_32x32x16_bf16 v[48:63], a[204:207], a[92:95], v[48:63]
    s_waitcnt vmcnt(4)
    v_mfma_f32_32x32x16_bf16 v[48:63], a[212:215], a[100:103], v[48:63]
    s_waitcnt vmcnt(2)
    v_mfma_f32_32x32x16_bf16 v[48:63], a[220:223], a[108:111], v[48:63]
    v_mfma_f32_32x32x16_bf16 v[32:47], a[204:207], a[88:91], v[32:47]
    v_mfma_f32_32x32x16_bf16 v[32:47], a[212:215], a[96:99], v[32:47]
    v_mfma_f32_32x32x16_bf16 v[32:47], a[220:223], a[104:107], v[32:47]
    v_mfma_f32_32x32x16_bf16 v[80:95], a[200:203], a[92:95], v[80:95]
    s_nop 7
    v_cvt_pk_bf16_f32 v192, v48, v49
    v_cvt_pk_bf16_f32 v193, v50, v51
    v_cvt_pk_bf16_f32 v194, v52, v53
    v_cvt_pk_bf16_f32 v195, v54, v55
    v_mfma_f32_32x32x16_bf16 v[80:95], a[208:211], a[100:103], v[80:95]
    ds_write_b128 v15, v[192:195] offset:8192
    v_cvt_pk_bf16_f32 v196, v56, v57
    v_mfma_f32_32x32x16_bf16 v[80:95], a[216:219], a[108:111], v[80:95]
    v_cvt_pk_bf16_f32 v197, v58, v59
    v_cvt_pk_bf16_f32 v198, v60, v61
    v_cvt_pk_bf16_f32 v199, v62, v63
    v_mfma_f32_32x32x16_bf16 v[64:79], a[200:203], a[88:91], v[64:79]
    ds_write_b128 v15, v[196:199] offset:9216
    v_cvt_pk_bf16_f32 v184, v32, v33
    v_mfma_f32_32x32x16_bf16 v[64:79], a[208:211], a[96:99], v[64:79]
    v_cvt_pk_bf16_f32 v185, v34, v35
    v_cvt_pk_bf16_f32 v186, v36, v37
    v_cvt_pk_bf16_f32 v187, v38, v39
    v_mfma_f32_32x32x16_bf16 v[64:79], a[216:219], a[104:107], v[64:79]
    ds_write_b128 v15, v[184:187] offset:6144
    v_cvt_pk_bf16_f32 v188, v40, v41
    v_mfma_f32_32x32x16_bf16 v[96:111], v[128:131], a[224:227], 0
    v_cvt_pk_bf16_f32 v189, v42, v43
    v_cvt_pk_bf16_f32 v190, v44, v45
    v_cvt_pk_bf16_f32 v191, v46, v47
    v_mfma_f32_32x32x16_bf16 v[96:111], v[132:135], a[228:231], v[96:111]
    ds_write_b128 v15, v[188:191] offset:7168
    v_cvt_pk_bf16_f32 v176, v80, v81
    v_mfma_f32_32x32x16_bf16 v[96:111], v[136:139], a[232:235], v[96:111]
    v_cvt_pk_bf16_f32 v177, v82, v83
    v_cvt_pk_bf16_f32 v178, v84, v85
    v_cvt_pk_bf16_f32 v179, v86, v87
    v_mfma_f32_32x32x16_bf16 v[96:111], v[140:143], a[236:239], v[96:111]
    ds_write_b128 v15, v[176:179] offset:4096
    v_cvt_pk_bf16_f32 v180, v88, v89
    s_waitcnt lgkmcnt(8)
    v_mfma_f32_32x32x16_bf16 v[96:111], v[152:155], a[224:227], v[96:111]
    v_cvt_pk_bf16_f32 v181, v90, v91
    v_cvt_pk_bf16_f32 v182, v92, v93
    v_cvt_pk_bf16_f32 v183, v94, v95
    s_waitcnt lgkmcnt(7)
    v_mfma_f32_32x32x16_bf16 v[96:111], v[156:159], a[228:231], v[96:111]
    ds_write_b128 v15, v[180:183] offset:5120
    s_waitcnt lgkmcnt(0)
    v_mfma_f32_32x32x16_bf16 v[96:111], v[144:147], a[232:235], v[96:111]
    s_barrier
    ds_read_b128 v[200:203], v16 offset:4096
    ds_read_b128 v[204:207], v16 offset:5120
    ds_read_b128 v[208:211], v17 offset:6144
    ds_read_b128 v[212:215], v17 offset:7168
    ds_read_b128 v[216:219], v18 offset:8192
    ds_read_b128 v[220:223], v18 offset:9216
    v_mfma_f32_32x32x16_bf16 v[96:111], v[148:151], a[236:239], v[96:111]
    s_waitcnt vmcnt(0)
    v_lshlrev_b32 v112, 16, v232
    v_and_b32 v113, 0xffff0000, v232
    v_lshlrev_b32 v114, 16, v233
    v_and_b32 v115, 0xffff0000, v233
    v_lshlrev_b32 v116, 16, v234
    v_and_b32 v117, 0xffff0000, v234
    v_lshlrev_b32 v118, 16, v235
    s_waitcnt lgkmcnt(5)
    v_mfma_f32_32x32x16_bf16 v[64:79], a[240:243], v[200:203], v[64:79]
    v_and_b32 v119, 0xffff0000, v235
    v_lshlrev_b32 v120, 16, v236
    v_and_b32 v121, 0xffff0000, v236
    v_lshlrev_b32 v122, 16, v237
    v_and_b32 v123, 0xffff0000, v237
    v_lshlrev_b32 v124, 16, v238
    v_and_b32 v125, 0xffff0000, v238
    s_waitcnt lgkmcnt(4)
    v_mfma_f32_32x32x16_bf16 v[64:79], a[244:247], v[204:207], v[64:79]
    v_lshlrev_b32 v126, 16, v239
    v_and_b32 v127, 0xffff0000, v239
    v_mov_b32 v9, s65
    s_waitcnt lgkmcnt(3)
    v_mfma_f32_32x32x16_bf16 v[64:79], a[240:243], v[208:211], v[64:79]
    s_waitcnt lgkmcnt(2)
    v_mfma_f32_32x32x16_bf16 v[64:79], a[244:247], v[212:215], v[64:79]
    s_waitcnt lgkmcnt(1)
    v_mfma_f32_32x32x16_bf16 v[64:79], a[240:243], v[216:219], v[64:79]
    s_waitcnt lgkmcnt(0)
    v_mfma_f32_32x32x16_bf16 v[64:79], a[244:247], v[220:223], v[64:79]
    s_or_b32 s38, s2, s3
    s_cbranch_scc1 L_noep
    s_atomic_add s67, s[20:21], 0
L_noep:
    v_mov_b32 v8, 1.0
    s_nop 7
    v_pk_mul_f32 v[80:81], v[64:65], v[8:9] op_sel:[0,1] op_sel_hi:[1,1]
    v_pk_mul_f32 v[82:83], v[66:67], v[8:9] op_sel:[0,1] op_sel_hi:[1,1]
    v_pk_mul_f32 v[84:85], v[68:69], v[8:9] op_sel:[0,1] op_sel_hi:[1,1]
    v_pk_mul_f32 v[86:87], v[70:71], v[8:9] op_sel:[0,1] op_sel_hi:[1,1]
    v_exp_f32 v80, v80
    v_exp_f32 v81, v81
    v_exp_f32 v82, v82
    v_exp_f32 v83, v83
    v_exp_f32 v84, v84
    v_exp_f32 v85, v85
    v_exp_f32 v86, v86
    v_exp_f32 v87, v87
    v_pk_add_f32 v[80:81], v[80:81], v[8:9] op_sel_hi:[1,0]
    v_pk_add_f32 v[82:83], v[82:83], v[8:9] op_sel_hi:[1,0]
    v_pk_add_f32 v[84:85], v[84:85], v[8:9] op_sel_hi:[1,0]
    v_pk_add_f32 v[86:87], v[86:87], v[8:9] op_sel_hi:[1,0]
    v_rcp_f32 v80, v80
    v_rcp_f32 v81, v81
    v_rcp_f32 v82, v82
    v_rcp_f32 v83, v83
    v_rcp_f32 v84, v84
    v_rcp_f32 v85, v85
    v_rcp_f32 v86, v86
    v_rcp_f32 v87, v87
    v_pk_mul_f32 v[64:65], v[64:65], v[96:97]
    v_pk_mul_f32 v[66:67], v[66:67], v[98:99]
    v_pk_mul_f32 v[68:69], v[68:69], v[100:101]
    v_pk_mul_f32 v[70:71], v[70:71], v[102:103]
    v_pk_fma_f32 v[64:65], v[64:65], v[80:81], v[112:113]
    v_pk_fma_f32 v[66:67], v[66:67], v[82:83], v[114:115]
    v_pk_fma_f32 v[68:69], v[68:69], v[84:85], v[116:117]
    v_pk_fma_f32 v[70:71], v[70:71], v[86:87], v[118:119]
    v_cvt_pk_bf16_f32 v128, v64, v65
    v_cvt_pk_bf16_f32 v129, v66, v67
    v_cvt_pk_bf16_f32 v130, v68, v69
    v_cvt_pk_bf16_f32 v131, v70, v71
    buffer_store_dwordx4 v[128:131], v31, s[24:27], 0 offen offset:0
    v_pk_mul_f32 v[88:89], v[72:73], v[8:9] op_sel:[0,1] op_sel_hi:[1,1]
    v_pk_mul_f32 v[90:91], v[74:75], v[8:9] op_sel:[0,1] op_sel_hi:[1,1]
    v_pk_mul_f32 v[92:93], v[76:77], v[8:9] op_sel:[0,1] op_sel_hi:[1,1]
    v_pk_mul_f32 v[94:95], v[78:79], v[8:9] op_sel:[0,1] op_sel_hi:[1,1]
    v_exp_f32 v88, v88
    v_exp_f32 v89, v89
    v_exp_f32 v90, v90
    v_exp_f32 v91, v91
    v_exp_f32 v92, v92
    v_exp_f32 v93, v93
    v_exp_f32 v94, v94
    v_exp_f32 v95, v95
    v_pk_add_f32 v[88:89], v[88:89], v[8:9] op_sel_hi:[1,0]
    v_pk_add_f32 v[90:91], v[90:91], v[8:9] op_sel_hi:[1,0]
    v_pk_add_f32 v[92:93], v[92:93], v[8:9] op_sel_hi:[1,0]
    v_pk_add_f32 v[94:95], v[94:95], v[8:9] op_sel_hi:[1,0]
    v_rcp_f32 v88, v88
    v_rcp_f32 v89, v89
    v_rcp_f32 v90, v90
    v_rcp_f32 v91, v91
    v_rcp_f32 v92, v92
    v_rcp_f32 v93, v93
    v_rcp_f32 v94, v94
    v_rcp_f32 v95, v95
    v_pk_mul_f32 v[72:73], v[72:73], v[104:105]
    v_pk_mul_f32 v[74:75], v[74:75], v[106:107]
    v_pk_mul_f32 v[76:77], v[76:77], v[108:109]
    v_pk_mul_f32 v[78:79], v[78:79], v[110:111]
    v_pk_fma_f32 v[72:73], v[72:73], v[88:89], v[120:121]
    v_pk_fma_f32 v[74:75], v[74:75], v[90:91], v[122:123]
    v_pk_fma_f32 v[76:77], v[76:77], v[92:93], v[124:125]
    v_pk_fma_f32 v[78:79], v[78:79], v[94:95], v[126:127]
    v_cvt_pk_bf16_f32 v132, v72, v73
    v_cvt_pk_bf16_f32 v133, v74, v75
    v_cvt_pk_bf16_f32 v134, v76, v77
    v_cvt_pk_bf16_f32 v135, v78, v79
    buffer_store_dwordx4 v[132:135], v31, s[24:27], 0 offen offset:16
    s_endpgm
.p2alignl 6, 0xbf800000
L_f2:
    s_load_dwordx2 s[8:9], s[0:1], 8
    s_load_dwordx2 s[12:13], s[0:1], 16
    s_load_dwordx2 s[24:25], s[0:1], 56
    s_getpc_b64 s[68:69]
L_pc:
    s_sub_u32 s68, s68, L_pc-recurrent_scan__spectral_gfnet__glu_gated_glu__prompt_kernel
    s_subb_u32 s69, s69, 0
    s_sub_u32 s52, s51, 28
    v_lshlrev_b32 v2, 2, v0
    v_add_u32 v2, s52, v2
    v_lshlrev_b32 v2, 7, v2
    v_min_u32 v2, 34204, v2
    s_cmp_ge_u32 s3, 2
    s_cbranch_scc1 L_nocp
    global_load_dword a255, v2, s[68:69]
L_nocp:
    v_and_b32 v0, 63, v0
    s_waitcnt lgkmcnt(0)
    s_load_dword s36, s[20:21], 0
    s_mov_b32 s22, 268435456
    s_mov_b32 s23, 0x00020000
    s_lshl_b32 s28, s50, 2
    s_add_u32 s28, s28, s51
    s_sub_u32 s28, s28, 28
    s_nop 0
    s_mov_b32 s10, 921600
    s_mov_b32 s11, 0x00020000
    s_mov_b32 s14, 921600
    s_mov_b32 s15, 0x00020000
    s_cmp_eq_u32 s28, 0
    s_cselect_b32 s29, 32, 64
    s_cselect_b64 s[46:47], -1, 0
    v_lshlrev_b32 v24, 4, v0
    v_lshrrev_b32 v1, 5, v0
    v_and_b32 v2, 31, v0
    v_cmp_eq_u32 s[48:49], 0, v1
    v_and_b32 v3, 1, v0
    v_bfe_u32 v4, v0, 1, 4
    v_add_u32 v5, 0, v4
    v_mul_lo_u32 v6, v5, s29
    v_add_u32 v6, s28, v6
    v_cvt_f32_u32 v7, v3
    v_mul_f32 v7, 0x3e800000, v7
    v_xor_b32 v8, 1, v3
    v_or_b32 v8, v8, v6
    v_cmp_eq_u32 vcc, 0, v8
    v_mov_b32 v9, 1024
    s_nop 0
    v_cndmask_b32 v6, v6, v9, vcc
    v_cndmask_b32 v7, v7, 0, vcc
    v_cvt_f32_u32 v6, v6
    v_mul_f32 v6, 0x3a000000, v6
    v_lshlrev_b32 v8, 2, v1
    v_cvt_f32_u32 v8, v8
    v_fma_f32 v7, v8, v6, v7
    v_and_b32 v8, 1, v5
    v_cvt_f32_u32 v8, v8
    v_cndmask_b32 v12, 0, v8, s[46:47]
    v_sub_f32_e64 v10, 1.0, v12
    v_cndmask_b32 v11, 1.0, 0, s[46:47]
    s_lshl_b32 s52, s3, 3
    s_add_u32 s52, s52, 0
    s_mul_i32 s53, s52, s29
    s_add_u32 s53, s53, s28
    s_sub_u32 s54, 2048, s53
    s_cmp_eq_u32 s53, 0
    s_cselect_b32 s54, 1024, s54
    s_mul_i32 s53, s53, 450
    s_mul_i32 s54, s54, 450
    s_and_b32 s53, s53, -16
    s_and_b32 s54, s54, -16
    v_mov_b32 v20, s53
    v_mov_b32 v21, s54
    v_cndmask_b32 v20, v21, v20, s[48:49]
    v_lshl_add_u32 v20, v2, 4, v20
    s_lshl_b32 m0, s52, 10
    s_nop 0
    buffer_load_dwordx4 v20, s[8:11], 0 offen nt lds
    s_add_u32 m0, m0, 32768
    s_nop 0
    buffer_load_dwordx4 v20, s[12:15], 0 offen nt lds
    v_fmamk_f32 v8, v6, 0x00000000, v7
    v_cos_f32 v9, v8
    v_sin_f32 v8, v8
    v_mul_f32 v13, v9, v12
    v_fma_f32 v8, v8, v11, v13
    v_mul_f32 v9, v9, v10
    v_cvt_pk_bf16_f32 v8, v9, v8
    v_accvgpr_write_b32 a0, v8
    v_fmamk_f32 v8, v6, 0x40000000, v7
    v_cos_f32 v9, v8
    v_sin_f32 v8, v8
    v_mul_f32 v13, v9, v12
    v_fma_f32 v8, v8, v11, v13
    v_mul_f32 v9, v9, v10
    v_cvt_pk_bf16_f32 v8, v9, v8
    v_accvgpr_write_b32 a1, v8
    v_fmamk_f32 v8, v6, 0x3f800000, v7
    v_cos_f32 v9, v8
    v_sin_f32 v8, v8
    v_mul_f32 v13, v9, v12
    v_fma_f32 v8, v8, v11, v13
    v_mul_f32 v9, v9, v10
    v_cvt_pk_bf16_f32 v8, v9, v8
    v_accvgpr_write_b32 a2, v8
    v_fmamk_f32 v8, v6, 0x40400000, v7
    v_cos_f32 v9, v8
    v_sin_f32 v8, v8
    v_mul_f32 v13, v9, v12
    v_fma_f32 v8, v8, v11, v13
    v_mul_f32 v9, v9, v10
    v_cvt_pk_bf16_f32 v8, v9, v8
    v_accvgpr_write_b32 a3, v8
    s_lshl_b32 s52, s3, 3
    s_add_u32 s52, s52, 1
    s_mul_i32 s53, s52, s29
    s_add_u32 s53, s53, s28
    s_sub_u32 s54, 2048, s53
    s_cmp_eq_u32 s53, 0
    s_cselect_b32 s54, 1024, s54
    s_mul_i32 s53, s53, 450
    s_mul_i32 s54, s54, 450
    s_and_b32 s53, s53, -16
    s_and_b32 s54, s54, -16
    v_mov_b32 v20, s53
    v_mov_b32_e64 v21, s54
    v_cndmask_b32 v20, v21, v20, s[48:49]
    v_lshl_add_u32 v20, v2, 4, v20
    s_lshl_b32 m0, s52, 10
    s_nop 0
    buffer_load_dwordx4 v20, s[8:11], 0 offen nt lds
    s_add_u32 m0, m0, 32768
    s_nop 0
    buffer_load_dwordx4 v20, s[12:15], 0 offen nt lds
    v_fmamk_f32 v8, v6, 0x41000000, v7
    v_cos_f32 v9, v8
    v_sin_f32 v8, v8
    v_mul_f32 v13, v9, v12
    v_fma_f32 v8, v8, v11, v13
    v_mul_f32_e64 v9, v9, v10
    v_cvt_pk_bf16_f32 v8, v9, v8
    v_accvgpr_write_b32 a4, v8
    v_fmamk_f32 v8, v6, 0x41200000, v7
    v_cos_f32 v9, v8
    v_sin_f32 v8, v8
    v_mul_f32 v13, v9, v12
    v_fma_f32 v8, v8, v11, v13
    v_mul_f32 v9, v9, v10
    v_cvt_pk_bf16_f32 v8, v9, v8
    v_accvgpr_write_b32 a5, v8
    v_fmamk_f32 v8, v6, 0x41100000, v7
    v_cos_f32 v9, v8
    v_sin_f32 v8, v8
    v_mul_f32 v13, v9, v12
    v_fma_f32 v8, v8, v11, v13
    v_mul_f32 v9, v9, v10
    v_cvt_pk_bf16_f32 v8, v9, v8
    v_accvgpr_write_b32 a6, v8
    v_fmamk_f32 v8, v6, 0x41300000, v7
    v_cos_f32 v9, v8
    v_sin_f32 v8, v8
    v_mul_f32 v13, v9, v12
    v_fma_f32 v8, v8, v11, v13
    v_mul_f32 v9, v9, v10
    v_cvt_pk_bf16_f32 v8, v9, v8
    v_accvgpr_write_b32 a7, v8
    s_mul_i32 s60, s28, 4224
    s_add_u32 s60, s60, 131072
    s_lshl_b32 s61, s3, 10
    s_add_u32 s61, s61, s60
    s_cmp_gt_u32 s28, 16
    s_cselect_b32 s61, 1073741824, s61
    s_waitcnt lgkmcnt(0)
    s_mul_i32 s30, s36, 0x9e3779b1
    s_add_u32 s30, s30, 0x7f4a7c15
    s_lshr_b32 s30, s30, 2
    s_bitset1_b32 s30, 30
    v_mov_b32 v16, s30
    v_mov_b32 v17, s30
    v_mov_b32 v18, s30
    v_mov_b32 v19, s30
    buffer_store_dwordx4 v[16:19], v24, s[20:23], s61 offen sc1
    s_mov_b32 s62, 1
    s_lshl_b32 s52, s3, 3
    s_add_u32 s52, s52, 2
    s_mul_i32 s53, s52, s29
    s_add_u32 s53, s53, s28
    s_sub_u32 s54, 2048, s53
    s_cmp_eq_u32 s53, 0
    s_cselect_b32 s54, 1024, s54
    s_nop 0
    s_mul_i32 s53, s53, 450
    s_mul_i32 s54, s54, 450
    s_and_b32 s53, s53, -16
    s_and_b32 s54, s54, -16
    v_mov_b32 v20, s53
    v_mov_b32 v21, s54
    v_cndmask_b32 v20, v21, v20, s[48:49]
    v_lshl_add_u32 v20, v2, 4, v20
    s_lshl_b32 m0, s52, 10
    s_nop 0
    buffer_load_dwordx4 v20, s[8:11], 0 offen nt lds
    s_add_u32 m0, m0, 32768
    s_nop 0
    buffer_load_dwordx4 v20, s[12:15], 0 offen nt lds
    v_fmamk_f32 v8, v6, 0x41800000, v7
    v_cos_f32 v9, v8
    v_sin_f32 v8, v8
    v_mul_f32 v13, v9, v12
    v_fma_f32 v8, v8, v11, v13
    v_mul_f32_e64 v9, v9, v10
    v_cvt_pk_bf16_f32 v8, v9, v8
    v_accvgpr_write_b32 a8, v8
    v_fmamk_f32 v8, v6, 0x41900000, v7
    v_cos_f32 v9, v8
    v_sin_f32 v8, v8
    v_mul_f32_e64 v13, v9, v12
    v_fma_f32 v8, v8, v11, v13
    v_mul_f32_e64 v9, v9, v10
    v_cvt_pk_bf16_f32 v8, v9, v8
    v_accvgpr_write_b32 a9, v8
    v_fmamk_f32 v8, v6, 0x41880000, v7
    v_cos_f32 v9, v8
    v_sin_f32 v8, v8
    v_mul_f32 v13, v9, v12
    v_fma_f32 v8, v8, v11, v13
    v_mul_f32 v9, v9, v10
    v_cvt_pk_bf16_f32 v8, v9, v8
    v_accvgpr_write_b32 a10, v8
    v_fmamk_f32 v8, v6, 0x41980000, v7
    v_cos_f32 v9, v8
    v_sin_f32 v8, v8
    v_mul_f32 v13, v9, v12
    v_fma_f32 v8, v8, v11, v13
    v_mul_f32 v9, v9, v10
    v_cvt_pk_bf16_f32 v8, v9, v8
    v_accvgpr_write_b32 a11, v8
    s_mov_b64 exec, 0
    s_cmp_eq_u32 s3, 0
    s_cbranch_scc1 L_padf0
    s_cmp_eq_u32 s3, 1
    s_cbranch_scc1 L_padf1
    s_cmp_eq_u32 s3, 2
    s_cbranch_scc1 L_padf2
    s_branch L_padf3
L_padf2:
L_padf3:
L_padf4:
L_padf5:
L_hbf:
    s_mov_b64 exec, -1
    s_lshl_b32 s52, s3, 3
    s_add_u32 s52, s52, 3
    s_mul_i32 s53, s52, s29
    s_add_u32 s53, s53, s28
    s_sub_u32 s54, 2048, s53
    s_cmp_eq_u32 s53, 0
    s_cselect_b32 s54, 1024, s54
    s_mul_i32 s53, s53, 450
    s_mul_i32 s54, s54, 450
    s_and_b32 s53, s53, -16
    s_and_b32 s54, s54, -16
    v_mov_b32 v20, s53
    v_mov_b32 v21, s54
    v_cndmask_b32 v20, v21, v20, s[48:49]
    v_lshl_add_u32 v20, v2, 4, v20
    s_lshl_b32 m0, s52, 10
    s_nop 0
    buffer_load_dwordx4 v20, s[8:11], 0 offen nt lds
    s_add_u32 m0, m0, 32768
    s_nop 0
    buffer_load_dwordx4 v20, s[12:15], 0 offen nt lds
    v_fmamk_f32 v8, v6, 0x41c00000, v7
    v_cos_f32 v9, v8
    v_sin_f32 v8, v8
    v_mul_f32 v13, v9, v12
    v_fma_f32 v8, v8, v11, v13
    v_mul_f32_e64 v9, v9, v10
    v_cvt_pk_bf16_f32 v8, v9, v8
    v_accvgpr_write_b32 a12, v8
    v_fmamk_f32 v8, v6, 0x41d00000, v7
    v_cos_f32 v9, v8
    v_sin_f32 v8, v8
    v_mul_f32 v13, v9, v12
    v_fma_f32 v8, v8, v11, v13
    v_mul_f32 v9, v9, v10
    v_cvt_pk_bf16_f32 v8, v9, v8
    v_accvgpr_write_b32 a13, v8
    v_fmamk_f32 v8, v6, 0x41c80000, v7
    v_cos_f32 v9, v8
    v_sin_f32 v8, v8
    v_mul_f32 v13, v9, v12
    v_fma_f32 v8, v8, v11, v13
    v_mul_f32 v9, v9, v10
    v_cvt_pk_bf16_f32 v8, v9, v8
    v_accvgpr_write_b32 a14, v8
    v_fmamk_f32 v8, v6, 0x41d80000, v7
    v_cos_f32 v9, v8
    v_sin_f32 v8, v8
    v_mul_f32 v13, v9, v12
    v_fma_f32 v8, v8, v11, v13
    v_mul_f32 v9, v9, v10
    v_cvt_pk_bf16_f32 v8, v9, v8
    v_accvgpr_write_b32 a15, v8
    v_add_u32 v5, 16, v4
    v_mul_lo_u32 v6, v5, s29
    v_add_u32 v6, s28, v6
    v_cvt_f32_u32 v7, v3
    v_mul_f32 v7, 0x3e800000, v7
    v_xor_b32 v8, 1, v3
    v_or_b32 v8, v8, v6
    v_cmp_eq_u32 vcc, 0, v8
    v_mov_b32 v9, 1024
    s_nop 0
    v_cndmask_b32 v6, v6, v9, vcc
    v_cndmask_b32 v7, v7, 0, vcc
    v_cvt_f32_u32 v6, v6
    v_mul_f32 v6, 0x3a000000, v6
    v_lshlrev_b32 v8, 2, v1
    v_cvt_f32_u32 v8, v8
    v_fma_f32 v7, v8, v6, v7
    v_and_b32 v8, 1, v5
    v_cvt_f32_u32 v8, v8
    v_cndmask_b32 v12, 0, v8, s[46:47]
    v_sub_f32 v10, 1.0, v12
    v_cndmask_b32 v11, 1.0, 0, s[46:47]
    s_lshl_b32 s52, s3, 3
    s_add_u32 s52, s52, 4
    s_mul_i32 s53, s52, s29
    s_add_u32 s53, s53, s28
    s_sub_u32 s54, 2048, s53
    s_cmp_eq_u32 s53, 0
    s_cselect_b32 s54, 1024, s54
    s_nop 0
    s_mul_i32 s53, s53, 450
    s_mul_i32 s54, s54, 450
    s_and_b32 s53, s53, -16
    s_and_b32 s54, s54, -16
    v_mov_b32 v20, s53
    v_mov_b32 v21, s54
    v_cndmask_b32 v20, v21, v20, s[48:49]
    v_lshl_add_u32 v20, v2, 4, v20
    s_lshl_b32 m0, s52, 10
    s_nop 0
    buffer_load_dwordx4 v20, s[8:11], 0 offen nt lds
    s_add_u32 m0, m0, 32768
    s_nop 0
    buffer_load_dwordx4 v20, s[12:15], 0 offen nt lds
    v_fmamk_f32 v8, v6, 0x00000000, v7
    v_cos_f32 v9, v8
    v_sin_f32 v8, v8
    v_mul_f32 v13, v9, v12
    v_fma_f32 v8, v8, v11, v13
    v_mul_f32_e64 v9, v9, v10
    v_cvt_pk_bf16_f32 v8, v9, v8
    v_accvgpr_write_b32 a16, v8
    v_fmamk_f32 v8, v6, 0x40000000, v7
    v_cos_f32 v9, v8
    v_sin_f32 v8, v8
    v_mul_f32_e64 v13, v9, v12
    v_fma_f32 v8, v8, v11, v13
    v_mul_f32_e64 v9, v9, v10
    v_cvt_pk_bf16_f32 v8, v9, v8
    v_accvgpr_write_b32 a17, v8
    v_fmamk_f32 v8, v6, 0x3f800000, v7
    v_cos_f32 v9, v8
    v_sin_f32 v8, v8
    v_mul_f32 v13, v9, v12
    v_fma_f32 v8, v8, v11, v13
    v_mul_f32 v9, v9, v10
    v_cvt_pk_bf16_f32 v8, v9, v8
    v_accvgpr_write_b32 a18, v8
    v_fmamk_f32 v8, v6, 0x40400000, v7
    v_cos_f32 v9, v8
    v_sin_f32 v8, v8
    v_mul_f32 v13, v9, v12
    v_fma_f32 v8, v8, v11, v13
    v_mul_f32 v9, v9, v10
    v_cvt_pk_bf16_f32 v8, v9, v8
    v_accvgpr_write_b32 a19, v8
    s_waitcnt vmcnt(6)
    s_barrier
    s_cmp_lg_u32 s61, s60
    s_cbranch_scc1 L_noinit
    s_atomic_add s62, s[20:21], s60 offset:3968
L_noinit:
    s_lshl_b32 s58, s3, 22
    s_nop 0
    s_add_u32 s59, s58, 0x200000
    s_load_dword s64, s[24:25], 0
    s_load_dword s64, s[20:21], s58 offset:0x80000
    s_load_dword s64, s[20:21], s59 offset:0x80000
    s_lshl_b32 s52, s3, 3
    s_add_u32 s52, s52, 5
    s_mul_i32 s53, s52, s29
    s_add_u32 s53, s53, s28
    s_sub_u32 s54, 2048, s53
    s_cmp_eq_u32 s53, 0
    s_cselect_b32 s54, 1024, s54
    s_mul_i32 s53, s53, 450
    s_mul_i32 s54, s54, 450
    s_and_b32 s53, s53, -16
    s_and_b32 s54, s54, -16
    v_mov_b32 v20, s53
    v_mov_b32_e64 v21, s54
    v_cndmask_b32 v20, v21, v20, s[48:49]
    v_lshl_add_u32 v20, v2, 4, v20
    s_lshl_b32 m0, s52, 10
    s_nop 0
    buffer_load_dwordx4 v20, s[8:11], 0 offen nt lds
    s_add_u32 m0, m0, 32768
    s_nop 0
    buffer_load_dwordx4 v20, s[12:15], 0 offen nt lds
    v_fmamk_f32 v8, v6, 0x41000000, v7
    v_cos_f32 v9, v8
    v_sin_f32 v8, v8
    v_mul_f32 v13, v9, v12
    v_fma_f32 v8, v8, v11, v13
    v_mul_f32_e64 v9, v9, v10
    v_cvt_pk_bf16_f32 v8, v9, v8
    v_accvgpr_write_b32 a20, v8
    v_fmamk_f32 v8, v6, 0x41200000, v7
    v_cos_f32 v9, v8
    v_sin_f32 v8, v8
    v_mul_f32 v13, v9, v12
    v_fma_f32 v8, v8, v11, v13
    v_mul_f32 v9, v9, v10
    v_cvt_pk_bf16_f32 v8, v9, v8
    v_accvgpr_write_b32 a21, v8
    v_fmamk_f32 v8, v6, 0x41100000, v7
    v_cos_f32 v9, v8
    v_sin_f32 v8, v8
    v_mul_f32 v13, v9, v12
    v_fma_f32 v8, v8, v11, v13
    v_mul_f32 v9, v9, v10
    v_cvt_pk_bf16_f32 v8, v9, v8
    v_accvgpr_write_b32 a22, v8
    v_fmamk_f32 v8, v6, 0x41300000, v7
    v_cos_f32 v9, v8
    v_sin_f32 v8, v8
    v_mul_f32 v13, v9, v12
    v_fma_f32 v8, v8, v11, v13
    v_mul_f32 v9, v9, v10
    v_cvt_pk_bf16_f32 v8, v9, v8
    v_accvgpr_write_b32 a23, v8
    s_lshl_b32 s52, s3, 3
    s_add_u32 s52, s52, 6
    s_mul_i32 s53, s52, s29
    s_add_u32 s53, s53, s28
    s_sub_u32 s54, 2048, s53
    s_cmp_eq_u32 s53, 0
    s_cselect_b32 s54, 1024, s54
    s_mul_i32 s53, s53, 450
    s_mul_i32 s54, s54, 450
    s_and_b32 s53, s53, -16
    s_and_b32 s54, s54, -16
    v_mov_b32 v20, s53
    v_mov_b32_e64 v21, s54
    v_cndmask_b32 v20, v21, v20, s[48:49]
    v_lshl_add_u32 v20, v2, 4, v20
    s_lshl_b32 m0, s52, 10
    s_nop 0
    buffer_load_dwordx4 v20, s[8:11], 0 offen nt lds
    s_add_u32 m0, m0, 32768
    s_nop 0
    buffer_load_dwordx4 v20, s[12:15], 0 offen nt lds
    v_fmamk_f32 v8, v6, 0x41800000, v7
    v_cos_f32 v9, v8
    v_sin_f32 v8, v8
    v_mul_f32 v13, v9, v12
    v_fma_f32 v8, v8, v11, v13
    v_mul_f32_e64 v9, v9, v10
    v_cvt_pk_bf16_f32 v8, v9, v8
    v_accvgpr_write_b32 a24, v8
    v_fmamk_f32 v8, v6, 0x41900000, v7
    v_cos_f32 v9, v8
    v_sin_f32 v8, v8
    v_mul_f32 v13, v9, v12
    v_fma_f32 v8, v8, v11, v13
    v_mul_f32 v9, v9, v10
    v_cvt_pk_bf16_f32 v8, v9, v8
    v_accvgpr_write_b32 a25, v8
    v_fmamk_f32 v8, v6, 0x41880000, v7
    v_cos_f32 v9, v8
    v_sin_f32 v8, v8
    v_mul_f32 v13, v9, v12
    v_fma_f32 v8, v8, v11, v13
    v_mul_f32 v9, v9, v10
    v_cvt_pk_bf16_f32 v8, v9, v8
    v_accvgpr_write_b32 a26, v8
    v_fmamk_f32 v8, v6, 0x41980000, v7
    v_cos_f32 v9, v8
    v_sin_f32 v8, v8
    v_mul_f32 v13, v9, v12
    v_fma_f32 v8, v8, v11, v13
    v_mul_f32 v9, v9, v10
    v_cvt_pk_bf16_f32 v8, v9, v8
    v_accvgpr_write_b32 a27, v8
    s_lshl_b32 s52, s3, 3
    s_add_u32 s52, s52, 7
    s_mul_i32 s53, s52, s29
    s_add_u32 s53, s53, s28
    s_sub_u32 s54, 2048, s53
    s_cmp_eq_u32 s53, 0
    s_cselect_b32 s54, 1024, s54
    s_mul_i32 s53, s53, 450
    s_mul_i32 s54, s54, 450
    s_and_b32 s53, s53, -16
    s_and_b32 s54, s54, -16
    v_mov_b32 v20, s53
    v_mov_b32_e64 v21, s54
    v_cndmask_b32 v20, v21, v20, s[48:49]
    v_lshl_add_u32 v20, v2, 4, v20
    s_lshl_b32 m0, s52, 10
    s_nop 0
    buffer_load_dwordx4 v20, s[8:11], 0 offen nt lds
    s_add_u32 m0, m0, 32768
    s_nop 0
    buffer_load_dwordx4 v20, s[12:15], 0 offen nt lds
    v_fmamk_f32 v8, v6, 0x41c00000, v7
    v_cos_f32 v9, v8
    v_sin_f32 v8, v8
    v_mul_f32 v13, v9, v12
    v_fma_f32 v8, v8, v11, v13
    v_mul_f32_e64 v9, v9, v10
    v_cvt_pk_bf16_f32 v8, v9, v8
    v_accvgpr_write_b32 a28, v8
    v_fmamk_f32 v8, v6, 0x41d00000, v7
    v_cos_f32 v9, v8
    v_sin_f32 v8, v8
    v_mul_f32 v13, v9, v12
    v_fma_f32 v8, v8, v11, v13
    v_mul_f32 v9, v9, v10
    v_cvt_pk_bf16_f32 v8, v9, v8
    v_accvgpr_write_b32 a29, v8
    v_fmamk_f32 v8, v6, 0x41c80000, v7
    v_cos_f32 v9, v8
    v_sin_f32 v8, v8
    v_mul_f32 v13, v9, v12
    v_fma_f32 v8, v8, v11, v13
    v_mul_f32 v9, v9, v10
    v_cvt_pk_bf16_f32 v8, v9, v8
    v_accvgpr_write_b32 a30, v8
    v_fmamk_f32 v8, v6, 0x41d80000, v7
    v_cos_f32 v9, v8
    v_sin_f32 v8, v8
    v_mul_f32 v13, v9, v12
    v_fma_f32 v8, v8, v11, v13
    v_mul_f32 v9, v9, v10
    v_cvt_pk_bf16_f32 v8, v9, v8
    v_accvgpr_write_b32 a31, v8
    v_add_u32 v5, 0, v4
    v_cvt_f32_u32 v6, v5
    v_mul_f32 v6, 0x3a000000, v6
    v_cvt_f32_u32_e64 v7, v3
    v_mul_f32 v7, 0xbe800000, v7
    v_cndmask_b32 v7, v7, 0, s[46:47]
    v_lshlrev_b32 v8, 1, v1
    v_mul_lo_u32 v8, v8, s29
    v_add_u32 v14, s28, v8
    v_cvt_f32_u32_e64 v8, v14
    v_fma_f32 v7, v8, v6, v7
    v_cvt_f32_u32 v8, s29
    v_mul_f32 v6, v6, v8
    v_cvt_f32_u32 v8, v3
    v_cndmask_b32 v11, 1.0, v8, s[46:47]
    v_sub_f32 v8, 1.0, v8
    v_cndmask_b32 v10, 1.0, v8, s[46:47]
    v_lshlrev_b32 v12, 31, v5
    v_xor_b32 v12, -1.0, v12
    v_fmamk_f32 v8, v6, 0x00000000, v7
    v_cos_f32 v9, v8
    v_sin_f32 v8, v8
    v_cmp_eq_u32 vcc, 0, v14
    s_nop 1
    v_cndmask_b32 v8, v8, v12, vcc
    v_mul_f32 v9, v9, v10
    v_mul_f32_e64 v8, v8, v10
    v_cvt_pk_bf16_f32 v8, v9, -v8
    v_accvgpr_write_b32 a32, v8
    v_fmamk_f32 v8, v6, 0x3f800000, v7
    v_cos_f32 v9, v8
    v_sin_f32 v8, v8
    v_mul_f32 v9, v9, v11
    v_mul_f32 v8, v8, v11
    v_cvt_pk_bf16_f32 v8, v9, -v8
    v_accvgpr_write_b32 a33, v8
    v_fmamk_f32 v8, v6, 0x40800000, v7
    v_cos_f32 v9, v8
    v_sin_f32 v8, v8
    v_mul_f32 v9, v9, v10
    v_mul_f32 v8, v8, v10
    v_cvt_pk_bf16_f32 v8, v9, -v8
    v_accvgpr_write_b32 a34, v8
    v_fmamk_f32 v8, v6, 0x40a00000, v7
    v_cos_f32 v9, v8
    v_sin_f32 v8, v8
    v_mul_f32 v9, v9, v11
    v_mul_f32 v8, v8, v11
    v_cvt_pk_bf16_f32 v8, v9, -v8
    v_accvgpr_write_b32 a35, v8
    v_fmamk_f32 v8, v6, 0x41000000, v7
    v_cos_f32 v9, v8
    v_sin_f32 v8, v8
    v_mul_f32 v9, v9, v10
    v_mul_f32 v8, v8, v10
    v_cvt_pk_bf16_f32 v8, v9, -v8
    v_accvgpr_write_b32 a36, v8
    v_fmamk_f32 v8, v6, 0x41100000, v7
    v_cos_f32 v9, v8
    v_sin_f32 v8, v8
    v_mul_f32 v9, v9, v11
    v_mul_f32 v8, v8, v11
    v_cvt_pk_bf16_f32 v8, v9, -v8
    v_accvgpr_write_b32 a37, v8
    v_fmamk_f32 v8, v6, 0x41400000, v7
    v_cos_f32 v9, v8
    v_sin_f32 v8, v8
    v_mul_f32 v9, v9, v10
    v_mul_f32 v8, v8, v10
    v_cvt_pk_bf16_f32 v8, v9, -v8
    v_accvgpr_write_b32 a38, v8
    v_fmamk_f32 v8, v6, 0x41500000, v7
    v_cos_f32 v9, v8
    v_sin_f32 v8, v8
    v_mul_f32 v9, v9, v11
    v_mul_f32 v8, v8, v11
    v_cvt_pk_bf16_f32 v8, v9, -v8
    v_accvgpr_write_b32 a39, v8
    v_fmamk_f32 v8, v6, 0x41800000, v7
    v_cos_f32 v9, v8
    v_sin_f32 v8, v8
    v_mul_f32 v9, v9, v10
    v_mul_f32 v8, v8, v10
    v_cvt_pk_bf16_f32 v8, v9, -v8
    v_accvgpr_write_b32 a40, v8
    v_fmamk_f32 v8, v6, 0x41880000, v7
    v_cos_f32 v9, v8
    v_sin_f32 v8, v8
    v_mul_f32 v9, v9, v11
    v_mul_f32 v8, v8, v11
    v_cvt_pk_bf16_f32 v8, v9, -v8
    v_accvgpr_write_b32 a41, v8
    v_fmamk_f32 v8, v6, 0x41a00000, v7
    v_cos_f32 v9, v8
    v_sin_f32 v8, v8
    v_mul_f32 v9, v9, v10
    v_mul_f32 v8, v8, v10
    v_cvt_pk_bf16_f32 v8, v9, -v8
    v_accvgpr_write_b32 a42, v8
    v_fmamk_f32 v8, v6, 0x41a80000, v7
    v_cos_f32 v9, v8
    v_sin_f32 v8, v8
    v_mul_f32 v9, v9, v11
    v_mul_f32 v8, v8, v11
    v_cvt_pk_bf16_f32 v8, v9, -v8
    v_accvgpr_write_b32 a43, v8
    v_fmamk_f32 v8, v6, 0x41c00000, v7
    v_cos_f32 v9, v8
    v_sin_f32 v8, v8
    v_mul_f32 v9, v9, v10
    v_mul_f32 v8, v8, v10
    v_cvt_pk_bf16_f32 v8, v9, -v8
    v_accvgpr_write_b32 a44, v8
    v_fmamk_f32 v8, v6, 0x41c80000, v7
    v_cos_f32 v9, v8
    v_sin_f32 v8, v8
    v_mul_f32 v9, v9, v11
    v_mul_f32 v8, v8, v11
    v_cvt_pk_bf16_f32 v8, v9, -v8
    v_accvgpr_write_b32 a45, v8
    v_fmamk_f32 v8, v6, 0x41e00000, v7
    v_cos_f32 v9, v8
    v_sin_f32 v8, v8
    v_mul_f32 v9, v9, v10
    v_mul_f32 v8, v8, v10
    v_cvt_pk_bf16_f32 v8, v9, -v8
    v_accvgpr_write_b32 a46, v8
    v_fmamk_f32 v8, v6, 0x41e80000, v7
    v_cos_f32 v9, v8
    v_sin_f32 v8, v8
    v_mul_f32 v9, v9, v11
    v_mul_f32 v8, v8, v11
    v_cvt_pk_bf16_f32 v8, v9, -v8
    v_accvgpr_write_b32 a47, v8
    v_add_u32 v5, 16, v4
    v_cvt_f32_u32 v6, v5
    v_mul_f32 v6, 0x3a000000, v6
    v_cvt_f32_u32_e64 v7, v3
    v_mul_f32 v7, 0xbe800000, v7
    v_cndmask_b32 v7, v7, 0, s[46:47]
    v_lshlrev_b32 v8, 1, v1
    v_mul_lo_u32 v8, v8, s29
    v_add_u32 v14, s28, v8
    v_cvt_f32_u32_e64 v8, v14
    v_fma_f32 v7, v8, v6, v7
    v_cvt_f32_u32 v8, s29
    v_mul_f32 v6, v6, v8
    v_cvt_f32_u32 v8, v3
    v_cndmask_b32 v11, 1.0, v8, s[46:47]
    v_sub_f32 v8, 1.0, v8
    v_cndmask_b32 v10, 1.0, v8, s[46:47]
    v_lshlrev_b32 v12, 31, v5
    v_xor_b32 v12, -1.0, v12
    v_fmamk_f32 v8, v6, 0x00000000, v7
    v_cos_f32 v9, v8
    v_sin_f32 v8, v8
    v_cmp_eq_u32 vcc, 0, v14
    s_nop 1
    v_cndmask_b32 v8, v8, v12, vcc
    v_mul_f32 v9, v9, v10
    v_mul_f32_e64 v8, v8, v10
    v_cvt_pk_bf16_f32 v8, v9, -v8
    v_accvgpr_write_b32 a48, v8
    v_fmamk_f32 v8, v6, 0x3f800000, v7
    v_cos_f32 v9, v8
    v_sin_f32 v8, v8
    v_mul_f32 v9, v9, v11
    v_mul_f32 v8, v8, v11
    v_cvt_pk_bf16_f32 v8, v9, -v8
    v_accvgpr_write_b32 a49, v8
    v_fmamk_f32 v8, v6, 0x40800000, v7
    v_cos_f32 v9, v8
    v_sin_f32 v8, v8
    v_mul_f32 v9, v9, v10
    v_mul_f32 v8, v8, v10
    v_cvt_pk_bf16_f32 v8, v9, -v8
    v_accvgpr_write_b32 a50, v8
    v_fmamk_f32 v8, v6, 0x40a00000, v7
    v_cos_f32 v9, v8
    v_sin_f32 v8, v8
    v_mul_f32 v9, v9, v11
    v_mul_f32 v8, v8, v11
    v_cvt_pk_bf16_f32 v8, v9, -v8
    v_accvgpr_write_b32 a51, v8
    v_fmamk_f32 v8, v6, 0x41000000, v7
    v_cos_f32 v9, v8
    v_sin_f32 v8, v8
    v_mul_f32 v9, v9, v10
    v_mul_f32 v8, v8, v10
    v_cvt_pk_bf16_f32 v8, v9, -v8
    v_accvgpr_write_b32 a52, v8
    v_fmamk_f32 v8, v6, 0x41100000, v7
    v_cos_f32 v9, v8
    v_sin_f32 v8, v8
    v_mul_f32 v9, v9, v11
    v_mul_f32 v8, v8, v11
    v_cvt_pk_bf16_f32 v8, v9, -v8
    v_accvgpr_write_b32 a53, v8
    v_fmamk_f32 v8, v6, 0x41400000, v7
    v_cos_f32 v9, v8
    v_sin_f32 v8, v8
    v_mul_f32 v9, v9, v10
    v_mul_f32 v8, v8, v10
    v_cvt_pk_bf16_f32 v8, v9, -v8
    v_accvgpr_write_b32 a54, v8
    v_fmamk_f32 v8, v6, 0x41500000, v7
    v_cos_f32 v9, v8
    v_sin_f32 v8, v8
    v_mul_f32 v9, v9, v11
    v_mul_f32 v8, v8, v11
    v_cvt_pk_bf16_f32 v8, v9, -v8
    v_accvgpr_write_b32 a55, v8
    v_fmamk_f32 v8, v6, 0x41800000, v7
    v_cos_f32 v9, v8
    v_sin_f32 v8, v8
    v_mul_f32 v9, v9, v10
    v_mul_f32 v8, v8, v10
    v_cvt_pk_bf16_f32 v8, v9, -v8
    v_accvgpr_write_b32 a56, v8
    v_fmamk_f32 v8, v6, 0x41880000, v7
    v_cos_f32 v9, v8
    v_sin_f32 v8, v8
    v_mul_f32 v9, v9, v11
    v_mul_f32 v8, v8, v11
    v_cvt_pk_bf16_f32 v8, v9, -v8
    v_accvgpr_write_b32 a57, v8
    v_fmamk_f32 v8, v6, 0x41a00000, v7
    v_cos_f32 v9, v8
    v_sin_f32 v8, v8
    v_mul_f32 v9, v9, v10
    v_mul_f32 v8, v8, v10
    v_cvt_pk_bf16_f32 v8, v9, -v8
    v_accvgpr_write_b32 a58, v8
    v_fmamk_f32 v8, v6, 0x41a80000, v7
    v_cos_f32 v9, v8
    v_sin_f32 v8, v8
    v_mul_f32 v9, v9, v11
    v_mul_f32 v8, v8, v11
    v_cvt_pk_bf16_f32 v8, v9, -v8
    v_accvgpr_write_b32 a59, v8
    v_fmamk_f32 v8, v6, 0x41c00000, v7
    v_cos_f32 v9, v8
    v_sin_f32 v8, v8
    v_mul_f32 v9, v9, v10
    v_mul_f32 v8, v8, v10
    v_cvt_pk_bf16_f32 v8, v9, -v8
    v_accvgpr_write_b32 a60, v8
    v_fmamk_f32 v8, v6, 0x41c80000, v7
    v_cos_f32 v9, v8
    v_sin_f32 v8, v8
    v_mul_f32 v9, v9, v11
    v_mul_f32 v8, v8, v11
    v_cvt_pk_bf16_f32 v8, v9, -v8
    v_accvgpr_write_b32 a61, v8
    v_fmamk_f32 v8, v6, 0x41e00000, v7
    v_cos_f32 v9, v8
    v_sin_f32 v8, v8
    v_mul_f32 v9, v9, v10
    v_mul_f32 v8, v8, v10
    v_cvt_pk_bf16_f32 v8, v9, -v8
    v_accvgpr_write_b32 a62, v8
    v_fmamk_f32 v8, v6, 0x41e80000, v7
    v_cos_f32 v9, v8
    v_sin_f32 v8, v8
    v_mul_f32 v9, v9, v11
    v_mul_f32 v8, v8, v11
    v_cvt_pk_bf16_f32 v8, v9, -v8
    v_accvgpr_write_b32 a63, v8
    v_lshlrev_b32 v8, 9, v1
    v_lshl_add_u32 v8, v2, 2, v8
    s_lshl_b32 s34, s3, 14
    v_add_u32_e64 v8, s34, v8
    v_add_u32 v25, 128, v8
    v_mul_u32_u24 v9, 4224, v4
    v_lshl_add_u32 v9, v3, 8, v9
    s_add_u32 s63, s3, 1
    s_and_b32 s63, s63, 3
    s_mul_i32 s52, s28, 57344
    s_lshl_b32 s53, s63, 13
    s_add_u32 s52, s52, s53
    s_add_u32 s52, s52, 1048576
    s_add_u32 s53, s52, 24576
    s_cmp_eq_u32 s3, 3
    s_cselect_b32 s53, 1073741824, s53
    s_lshr_b32 s56, s28, 4
    s_lshl_b32 s54, s56, 7
    s_add_u32 s54, s54, 133120
    s_mov_b32 s48, -1
    s_mov_b32 s49, 0
    s_mul_i32 s56, s56, 28672
    s_and_b32 s57, s28, 15
    s_lshl_b32 s57, s57, 7
    s_add_u32 s56, s56, s57
    s_lshl_b32 s57, s63, 11
    s_add_u32 s56, s56, s57
    s_add_u32 s56, s56, 3145728
    v_lshrrev_b32 v5, 3, v0
    v_and_b32 v6, 7, v0
    v_mul_u32_u24 v10, 57344, v5
    v_lshl_add_u32 v10, v6, 4, v10
    s_lshl_b32 s58, s3, 13
    s_add_u32 s58, s58, 131072
    v_and_b32 v7, 3, v5
    v_lshlrev_b32 v7, 1, v7
    v_xor_b32 v7, v7, v6
    v_lshlrev_b32 v7, 4, v7
    v_lshl_add_u32 v7, v5, 7, v7
    v_add_u32_e64 v13, s58, v7
    s_bfe_u32 s59, s28, 131073
    v_lshlrev_b32 v5, 1, v1
    v_xor_b32 v5, s59, v5
    v_and_b32 v6, 3, v4
    v_xor_b32 v5, v5, v6
    v_lshl_add_u32 v5, v5, 1, v3
    v_lshlrev_b32 v5, 4, v5
    v_lshl_add_u32 v5, v4, 7, v5
    v_add_u32 v11, s58, v5
    v_xor_b32 v12, 32, v11
    s_add_u32 s59, s54, 512
    v_mov_b32 v26, 1
    s_lshl_b32 s60, s3, 14
    s_add_u32 s60, s60, 65536
    v_lshl_add_u32 v28, v0, 3, s60
L_coef:
    v_bfe_u32 v5, v0, 2, 1
    v_bfe_u32 v6, v0, 3, 2
    v_and_b32 v7, 3, v0
    v_lshl_add_u32 v7, v6, 2, v7
    v_lshl_add_u32 v7, v5, 4, v7
    s_lshl_b32 s60, s63, 5
    v_add_u32 v7, s60, v7
    v_cmp_eq_u32 s[40:41], 0, v7
    s_lshl_b32 s60, s28, 1
    s_and_b32 s61, s60, 15
    s_sub_u32 s62, 0, s60
    s_and_b32 s62, s62, 15
    s_add_u32 s62, s62, 512
L_padf0:
    s_cbranch_execz L_padf4
    v_lshlrev_b32 v5, 11, v1
    v_lshl_add_u32 v6, v7, 1, v5
    v_add_u32 v192, s61, v6
    v_add_u32_e64 v193, s62, v6
    s_cmp_eq_u32 s3, 3
    s_cselect_b32 s60, 0, 192
    v_mov_b32 v5, s60
    v_mov_b32 v6, 448
    v_cndmask_b32 v6, v5, v6, s[40:41]
    v_add_u32 v194, v192, v6
    v_add_u32 v195, v193, v6
    s_mov_b32 s60, 0x36124925
    s_cmp_eq_u32 s28, 0
    s_cselect_b32 s60, 0x36924925, s60
    v_mov_b32 v196, s60
    v_mul_f32 v197, 0.5, v196
    v_cndmask_b32 v197, v196, v197, s[40:41]
    v_cndmask_b32 v198, v197, 0, s[40:41]
    v_or_b32 v6, s28, v1
    v_cmp_eq_u32 s[50:51], 0, v6
    v_mov_b32 v128, 0
    v_mov_b32 v129, 0
    v_mov_b32 v130, 0
    v_mov_b32 v131, 0
    v_mov_b32 v132, 0
    v_mov_b32 v133, 0
    v_mov_b32 v134, 0
    v_mov_b32 v135, 0
    v_mov_b32 v136, 0
    v_mov_b32 v137, 0
    v_mov_b32 v138, 0
    v_mov_b32 v139, 0
    v_mov_b32 v140, 0
    v_mov_b32 v141, 0
    v_mov_b32 v142, 0
    v_mov_b32 v143, 0
    v_mov_b32 v144, 0
    v_mov_b32 v145, 0
    v_mov_b32 v146, 0
    v_mov_b32 v147, 0
    v_mov_b32 v148, 0
    v_mov_b32 v149, 0
    v_mov_b32 v150, 0
    v_mov_b32 v151, 0
    s_waitcnt vmcnt(0)
    s_barrier
    ds_read_u16_d16_hi v128, v194 offset:0
    ds_read_u16_d16_hi v129, v194 offset:32768
    ds_read_u16_d16_hi v130, v195 offset:0
    s_nop 0
    ds_read_u16_d16_hi v131, v195 offset:32768
    ds_read_u16_d16_hi v132, v194 offset:1024
    ds_read_u16_d16_hi v133, v194 offset:33792
    ds_read_u16_d16_hi v134, v195 offset:1024
    ds_read_u16_d16_hi v135, v195 offset:33792
    ds_read_u16_d16_hi v136, v194 offset:4096
    ds_read_u16_d16_hi v137, v194 offset:36864
    ds_read_u16_d16_hi v138, v195 offset:4096
    ds_read_u16_d16_hi v139, v195 offset:36864
    s_waitcnt lgkmcnt(0)
    ds_read_u16_d16_hi v140, v194 offset:5120
    ds_read_u16_d16_hi v141, v194 offset:37888
    s_nop 0
    ds_read_u16_d16_hi v142, v195 offset:5120
    ds_read_u16_d16_hi v143, v195 offset:37888
    ds_read_u16_d16_hi v144, v194 offset:8192
    ds_read_u16_d16_hi v145, v194 offset:40960
    ds_read_u16_d16_hi v146, v195 offset:8192
    ds_read_u16_d16_hi v147, v195 offset:40960
    ds_read_u16_d16_hi v148, v194 offset:9216
    ds_read_u16_d16_hi v149, v194 offset:41984
    ds_read_u16_d16_hi v150, v195 offset:9216
    ds_read_u16_d16_hi v151, v195 offset:41984
    v_pk_add_f32 v[96:97], v[128:129], v[130:131] neg_hi:[0,1]
    v_pk_add_f32 v[160:161], v[128:129], v[130:131] op_sel:[1,1] op_sel_hi:[0,0] neg_hi:[1,0]
    v_cndmask_b32 v20, v96, v128, s[50:51]
    v_cndmask_b32 v21, v96, v130, s[50:51]
    v_cndmask_b32 v97, v97, 0, s[50:51]
    v_cndmask_b32 v22, v160, v129, s[50:51]
    v_cndmask_b32 v23, v160, v131, s[50:51]
    v_cndmask_b32 v161, v161, 0, s[50:51]
    v_pk_mul_f32 v[20:21], v[20:21], v[196:197] op_sel:[0,1] op_sel_hi:[1,1]
    v_pk_mul_f32 v[22:23], v[22:23], v[198:199] op_sel_hi:[1,0]
    v_pk_mul_f32 v[96:97], v[96:97], v[196:197] op_sel:[0,1] op_sel_hi:[1,1]
    v_pk_mul_f32 v[160:161], v[160:161], v[198:199] op_sel_hi:[1,0]
    v_pk_add_f32 v[98:99], v[132:133], v[134:135] neg_hi:[0,1]
    v_pk_add_f32 v[162:163], v[132:133], v[134:135] op_sel:[1,1] op_sel_hi:[0,0] neg_hi:[1,0]
    v_pk_mul_f32 v[98:99], v[98:99], v[196:197] op_sel:[0,1] op_sel_hi:[1,1]
    v_pk_mul_f32 v[162:163], v[162:163], v[198:199] op_sel_hi:[1,0]
    v_pk_add_f32 v[100:101], v[136:137], v[138:139] neg_hi:[0,1]
    v_pk_add_f32 v[164:165], v[136:137], v[138:139] op_sel:[1,1] op_sel_hi:[0,0] neg_hi:[1,0]
    v_pk_mul_f32 v[100:101], v[100:101], v[196:197] op_sel:[0,1] op_sel_hi:[1,1]
    v_pk_mul_f32 v[164:165], v[164:165], v[198:199] op_sel_hi:[1,0]
    s_waitcnt lgkmcnt(0)
    ds_read_u16_d16_hi v128, v194 offset:12288
    s_nop 0
    ds_read_u16_d16_hi v129, v194 offset:45056
    ds_read_u16_d16_hi v130, v195 offset:12288
    ds_read_u16_d16_hi v131, v195 offset:45056
    ds_read_u16_d16_hi v132, v194 offset:13312
    ds_read_u16_d16_hi v133, v194 offset:46080
    ds_read_u16_d16_hi v134, v195 offset:13312
    ds_read_u16_d16_hi v135, v195 offset:46080
    ds_read_u16_d16_hi v136, v194 offset:16384
    ds_read_u16_d16_hi v137, v194 offset:49152
    ds_read_u16_d16_hi v138, v195 offset:16384
    ds_read_u16_d16_hi v139, v195 offset:49152
    ds_write2st64_b64 v28, v[96:97], v[160:161] offset0:0 offset1:1
    ds_write2st64_b64 v28, v[98:99], v[162:163] offset0:2 offset1:3
    ds_write2st64_b64 v28, v[100:101], v[164:165] offset0:4 offset1:5
    v_pk_add_f32 v[102:103], v[140:141], v[142:143] neg_hi:[0,1]
    v_pk_add_f32 v[166:167], v[140:141], v[142:143] op_sel:[1,1] op_sel_hi:[0,0] neg_hi:[1,0]
    v_pk_mul_f32 v[102:103], v[102:103], v[196:197] op_sel:[0,1] op_sel_hi:[1,1]
    v_pk_mul_f32 v[166:167], v[166:167], v[198:199] op_sel_hi:[1,0]
    v_pk_add_f32 v[104:105], v[144:145], v[146:147] neg_hi:[0,1]
    v_pk_add_f32 v[168:169], v[144:145], v[146:147] op_sel:[1,1] op_sel_hi:[0,0] neg_hi:[1,0]
    v_pk_mul_f32 v[104:105], v[104:105], v[196:197] op_sel:[0,1] op_sel_hi:[1,1]
    v_pk_mul_f32 v[168:169], v[168:169], v[198:199] op_sel_hi:[1,0]
    v_pk_add_f32 v[106:107], v[148:149], v[150:151] neg_hi:[0,1]
    v_pk_add_f32 v[170:171], v[148:149], v[150:151] op_sel:[1,1] op_sel_hi:[0,0] neg_hi:[1,0]
    v_pk_mul_f32 v[106:107], v[106:107], v[196:197] op_sel:[0,1] op_sel_hi:[1,1]
    v_pk_mul_f32 v[170:171], v[170:171], v[198:199] op_sel_hi:[1,0]
    s_waitcnt lgkmcnt(0)
    ds_read_u16_d16_hi v140, v194 offset:17408
    s_nop 0
    ds_read_u16_d16_hi v141, v194 offset:50176
    ds_read_u16_d16_hi v142, v195 offset:17408
    ds_read_u16_d16_hi v143, v195 offset:50176
    ds_read_u16_d16_hi v144, v194 offset:20480
    ds_read_u16_d16_hi v145, v194 offset:53248
    ds_read_u16_d16_hi v146, v195 offset:20480
    ds_read_u16_d16_hi v147, v195 offset:53248
    ds_read_u16_d16_hi v148, v194 offset:21504
    ds_read_u16_d16_hi v149, v194 offset:54272
    ds_read_u16_d16_hi v150, v195 offset:21504
    ds_read_u16_d16_hi v151, v195 offset:54272
    ds_write2st64_b64 v28, v[102:103], v[166:167] offset0:6 offset1:7
    ds_write2st64_b64 v28, v[104:105], v[168:169] offset0:8 offset1:9
    ds_write2st64_b64 v28, v[106:107], v[170:171] offset0:10 offset1:11
    v_pk_add_f32 v[108:109], v[128:129], v[130:131] neg_hi:[0,1]
    v_pk_add_f32 v[160:161], v[128:129], v[130:131] op_sel:[1,1] op_sel_hi:[0,0] neg_hi:[1,0]
    v_pk_mul_f32 v[108:109], v[108:109], v[196:197] op_sel:[0,1] op_sel_hi:[1,1]
    v_pk_mul_f32 v[160:161], v[160:161], v[198:199] op_sel_hi:[1,0]
    v_pk_add_f32 v[110:111], v[132:133], v[134:135] neg_hi:[0,1]
    v_pk_add_f32 v[162:163], v[132:133], v[134:135] op_sel:[1,1] op_sel_hi:[0,0] neg_hi:[1,0]
    v_pk_mul_f32 v[110:111], v[110:111], v[196:197] op_sel:[0,1] op_sel_hi:[1,1]
    v_pk_mul_f32 v[162:163], v[162:163], v[198:199] op_sel_hi:[1,0]
    v_pk_add_f32 v[112:113], v[136:137], v[138:139] neg_hi:[0,1]
    v_pk_add_f32 v[164:165], v[136:137], v[138:139] op_sel:[1,1] op_sel_hi:[0,0] neg_hi:[1,0]
    v_pk_mul_f32 v[112:113], v[112:113], v[196:197] op_sel:[0,1] op_sel_hi:[1,1]
    v_pk_mul_f32 v[164:165], v[164:165], v[198:199] op_sel_hi:[1,0]
    s_waitcnt lgkmcnt(0)
    ds_read_u16_d16_hi v128, v194 offset:24576
    s_nop 0
    ds_read_u16_d16_hi v129, v194 offset:57344
    ds_read_u16_d16_hi v130, v195 offset:24576
    ds_read_u16_d16_hi v131, v195 offset:57344
    ds_read_u16_d16_hi v132, v194 offset:25600
    ds_read_u16_d16_hi v133, v194 offset:58368
    ds_read_u16_d16_hi v134, v195 offset:25600
    ds_read_u16_d16_hi v135, v195 offset:58368
    ds_read_u16_d16_hi v136, v194 offset:28672
    ds_read_u16_d16_hi v137, v194 offset:61440
    ds_read_u16_d16_hi v138, v195 offset:28672
    ds_read_u16_d16_hi v139, v195 offset:61440
    ds_write2st64_b64 v28, v[108:109], v[160:161] offset0:12 offset1:13
    ds_write2st64_b64 v28, v[110:111], v[162:163] offset0:14 offset1:15
    ds_write2st64_b64 v28, v[112:113], v[164:165] offset0:16 offset1:17
    v_pk_add_f32 v[114:115], v[140:141], v[142:143] neg_hi:[0,1]
    v_pk_add_f32 v[166:167], v[140:141], v[142:143] op_sel:[1,1] op_sel_hi:[0,0] neg_hi:[1,0]
    v_pk_mul_f32 v[114:115], v[114:115], v[196:197] op_sel:[0,1] op_sel_hi:[1,1]
    v_pk_mul_f32 v[166:167], v[166:167], v[198:199] op_sel_hi:[1,0]
    v_pk_add_f32 v[116:117], v[144:145], v[146:147] neg_hi:[0,1]
    v_pk_add_f32 v[168:169], v[144:145], v[146:147] op_sel:[1,1] op_sel_hi:[0,0] neg_hi:[1,0]
    v_pk_mul_f32 v[116:117], v[116:117], v[196:197] op_sel:[0,1] op_sel_hi:[1,1]
    v_pk_mul_f32 v[168:169], v[168:169], v[198:199] op_sel_hi:[1,0]
    v_pk_add_f32 v[118:119], v[148:149], v[150:151] neg_hi:[0,1]
    v_pk_add_f32 v[170:171], v[148:149], v[150:151] op_sel:[1,1] op_sel_hi:[0,0] neg_hi:[1,0]
    v_pk_mul_f32 v[118:119], v[118:119], v[196:197] op_sel:[0,1] op_sel_hi:[1,1]
    v_pk_mul_f32 v[170:171], v[170:171], v[198:199] op_sel_hi:[1,0]
    s_waitcnt lgkmcnt(0)
    ds_read_u16_d16_hi v140, v194 offset:29696
    s_nop 0
    ds_read_u16_d16_hi v141, v194 offset:62464
    ds_read_u16_d16_hi v142, v195 offset:29696
    ds_read_u16_d16_hi v143, v195 offset:62464
    ds_read_u16_d16_hi v144, v192 offset:0
    ds_read_u16_d16_hi v145, v192 offset:32768
    ds_read_u16_d16_hi v146, v193 offset:0
    ds_read_u16_d16_hi v147, v193 offset:32768
    ds_read_u16_d16_hi v148, v192 offset:1024
    ds_read_u16_d16_hi v149, v192 offset:33792
    ds_read_u16_d16_hi v150, v193 offset:1024
    ds_read_u16_d16_hi v151, v193 offset:33792
    ds_write2st64_b64 v28, v[114:115], v[166:167] offset0:18 offset1:19
    ds_write2st64_b64 v28, v[116:117], v[168:169] offset0:20 offset1:21
    ds_write2st64_b64 v28, v[118:119], v[170:171] offset0:22 offset1:23
    v_pk_add_f32 v[120:121], v[128:129], v[130:131] neg_hi:[0,1]
    v_pk_add_f32 v[160:161], v[128:129], v[130:131] op_sel:[1,1] op_sel_hi:[0,0] neg_hi:[1,0]
    v_pk_mul_f32 v[120:121], v[120:121], v[196:197] op_sel:[0,1] op_sel_hi:[1,1]
    v_pk_mul_f32 v[160:161], v[160:161], v[198:199] op_sel_hi:[1,0]
    v_pk_add_f32 v[122:123], v[132:133], v[134:135] neg_hi:[0,1]
    v_pk_add_f32 v[162:163], v[132:133], v[134:135] op_sel:[1,1] op_sel_hi:[0,0] neg_hi:[1,0]
    v_pk_mul_f32 v[122:123], v[122:123], v[196:197] op_sel:[0,1] op_sel_hi:[1,1]
    v_pk_mul_f32 v[162:163], v[162:163], v[198:199] op_sel_hi:[1,0]
    v_pk_add_f32 v[124:125], v[136:137], v[138:139] neg_hi:[0,1]
    v_pk_add_f32 v[164:165], v[136:137], v[138:139] op_sel:[1,1] op_sel_hi:[0,0] neg_hi:[1,0]
    v_pk_mul_f32 v[124:125], v[124:125], v[196:197] op_sel:[0,1] op_sel_hi:[1,1]
    v_pk_mul_f32 v[164:165], v[164:165], v[198:199] op_sel_hi:[1,0]
    s_waitcnt lgkmcnt(0)
    ds_read_u16_d16_hi v128, v192 offset:4096
    s_nop 0
    ds_read_u16_d16_hi v129, v192 offset:36864
    ds_read_u16_d16_hi v130, v193 offset:4096
    ds_read_u16_d16_hi v131, v193 offset:36864
    ds_read_u16_d16_hi v132, v192 offset:5120
    ds_read_u16_d16_hi v133, v192 offset:37888
    ds_read_u16_d16_hi v134, v193 offset:5120
    ds_read_u16_d16_hi v135, v193 offset:37888
    ds_read_u16_d16_hi v136, v192 offset:8192
    ds_read_u16_d16_hi v137, v192 offset:40960
    ds_read_u16_d16_hi v138, v193 offset:8192
    ds_read_u16_d16_hi v139, v193 offset:40960
    ds_write2st64_b64 v28, v[120:121], v[160:161] offset0:24 offset1:25
    ds_write2st64_b64 v28, v[122:123], v[162:163] offset0:26 offset1:27
    ds_write2st64_b64 v28, v[124:125], v[164:165] offset0:28 offset1:29
    v_pk_add_f32 v[126:127], v[140:141], v[142:143] neg_hi:[0,1]
    v_pk_add_f32 v[166:167], v[140:141], v[142:143] op_sel:[1,1] op_sel_hi:[0,0] neg_hi:[1,0]
    v_pk_mul_f32 v[126:127], v[126:127], v[196:197] op_sel:[0,1] op_sel_hi:[1,1]
    v_pk_mul_f32 v[166:167], v[166:167], v[198:199] op_sel_hi:[1,0]
    v_pk_add_f32 v[32:33], v[144:145], v[146:147] neg_hi:[0,1]
    v_pk_add_f32 v[34:35], v[144:145], v[146:147] op_sel:[1,1] op_sel_hi:[0,0] neg_hi:[1,0]
    v_cndmask_b32 v14, v32, v144, s[50:51]
    v_cndmask_b32 v15, v32, v146, s[50:51]
    v_cndmask_b32 v33, v33, 0, s[50:51]
    v_cndmask_b32 v16, v34, v145, s[50:51]
    v_cndmask_b32 v17, v34, v147, s[50:51]
    v_cndmask_b32 v35, v35, 0, s[50:51]
    v_pk_mul_f32 v[14:15], v[14:15], v[196:197] op_sel:[0,1] op_sel_hi:[1,1]
    v_pk_mul_f32 v[16:17], v[16:17], v[198:199] op_sel_hi:[1,0]
    v_pk_mul_f32 v[32:33], v[32:33], v[196:197] op_sel:[0,1] op_sel_hi:[1,1]
    v_pk_mul_f32 v[34:35], v[34:35], v[198:199] op_sel_hi:[1,0]
    v_pk_add_f32 v[36:37], v[148:149], v[150:151] neg_hi:[0,1]
    v_pk_add_f32 v[38:39], v[148:149], v[150:151] op_sel:[1,1] op_sel_hi:[0,0] neg_hi:[1,0]
    v_pk_mul_f32 v[36:37], v[36:37], v[196:197] op_sel:[0,1] op_sel_hi:[1,1]
    v_pk_mul_f32 v[38:39], v[38:39], v[198:199] op_sel_hi:[1,0]
    s_waitcnt lgkmcnt(0)
    ds_read_u16_d16_hi v140, v192 offset:9216
    s_nop 0
    ds_read_u16_d16_hi v141, v192 offset:41984
    ds_read_u16_d16_hi v142, v193 offset:9216
    ds_read_u16_d16_hi v143, v193 offset:41984
    ds_read_u16_d16_hi v144, v192 offset:12288
    ds_read_u16_d16_hi v145, v192 offset:45056
    ds_read_u16_d16_hi v146, v193 offset:12288
    ds_read_u16_d16_hi v147, v193 offset:45056
    ds_read_u16_d16_hi v148, v192 offset:13312
    ds_read_u16_d16_hi v149, v192 offset:46080
    ds_read_u16_d16_hi v150, v193 offset:13312
    ds_read_u16_d16_hi v151, v193 offset:46080
    ds_write2st64_b64 v28, v[126:127], v[166:167] offset0:30 offset1:31
    v_pk_add_f32 v[40:41], v[128:129], v[130:131] neg_hi:[0,1]
    v_pk_add_f32 v[42:43], v[128:129], v[130:131] op_sel:[1,1] op_sel_hi:[0,0] neg_hi:[1,0]
    v_pk_mul_f32 v[40:41], v[40:41], v[196:197] op_sel:[0,1] op_sel_hi:[1,1]
    v_pk_mul_f32 v[42:43], v[42:43], v[198:199] op_sel_hi:[1,0]
    v_pk_add_f32 v[44:45], v[132:133], v[134:135] neg_hi:[0,1]
    v_pk_add_f32 v[46:47], v[132:133], v[134:135] op_sel:[1,1] op_sel_hi:[0,0] neg_hi:[1,0]
    v_pk_mul_f32 v[44:45], v[44:45], v[196:197] op_sel:[0,1] op_sel_hi:[1,1]
    v_pk_mul_f32 v[46:47], v[46:47], v[198:199] op_sel_hi:[1,0]
    v_pk_add_f32 v[48:49], v[136:137], v[138:139] neg_hi:[0,1]
    v_pk_add_f32 v[50:51], v[136:137], v[138:139] op_sel:[1,1] op_sel_hi:[0,0] neg_hi:[1,0]
    v_pk_mul_f32 v[48:49], v[48:49], v[196:197] op_sel:[0,1] op_sel_hi:[1,1]
    v_pk_mul_f32 v[50:51], v[50:51], v[198:199] op_sel_hi:[1,0]
    s_waitcnt lgkmcnt(0)
    ds_read_u16_d16_hi v128, v192 offset:16384
    ds_read_u16_d16_hi v129, v192 offset:49152
    ds_read_u16_d16_hi v130, v193 offset:16384
    s_nop 0
    ds_read_u16_d16_hi v131, v193 offset:49152
    ds_read_u16_d16_hi v132, v192 offset:17408
    ds_read_u16_d16_hi v133, v192 offset:50176
    ds_read_u16_d16_hi v134, v193 offset:17408
    ds_read_u16_d16_hi v135, v193 offset:50176
    ds_read_u16_d16_hi v136, v192 offset:20480
    ds_read_u16_d16_hi v137, v192 offset:53248
    ds_read_u16_d16_hi v138, v193 offset:20480
    ds_read_u16_d16_hi v139, v193 offset:53248
    v_pk_add_f32 v[52:53], v[140:141], v[142:143] neg_hi:[0,1]
    v_pk_add_f32 v[54:55], v[140:141], v[142:143] op_sel:[1,1] op_sel_hi:[0,0] neg_hi:[1,0]
    v_pk_mul_f32 v[52:53], v[52:53], v[196:197] op_sel:[0,1] op_sel_hi:[1,1]
    v_pk_mul_f32 v[54:55], v[54:55], v[198:199] op_sel_hi:[1,0]
    v_pk_add_f32 v[56:57], v[144:145], v[146:147] neg_hi:[0,1]
    v_pk_add_f32 v[58:59], v[144:145], v[146:147] op_sel:[1,1] op_sel_hi:[0,0] neg_hi:[1,0]
    v_pk_mul_f32 v[56:57], v[56:57], v[196:197] op_sel:[0,1] op_sel_hi:[1,1]
    v_pk_mul_f32 v[58:59], v[58:59], v[198:199] op_sel_hi:[1,0]
    v_pk_add_f32 v[60:61], v[148:149], v[150:151] neg_hi:[0,1]
    v_pk_add_f32 v[62:63], v[148:149], v[150:151] op_sel:[1,1] op_sel_hi:[0,0] neg_hi:[1,0]
    v_pk_mul_f32 v[60:61], v[60:61], v[196:197] op_sel:[0,1] op_sel_hi:[1,1]
    v_pk_mul_f32 v[62:63], v[62:63], v[198:199] op_sel_hi:[1,0]
    s_waitcnt lgkmcnt(0)
    ds_read_u16_d16_hi v140, v192 offset:21504
    ds_read_u16_d16_hi v141, v192 offset:54272
    s_nop 0
    ds_read_u16_d16_hi v142, v193 offset:21504
    ds_read_u16_d16_hi v143, v193 offset:54272
    ds_read_u16_d16_hi v144, v192 offset:24576
    ds_read_u16_d16_hi v145, v192 offset:57344
    ds_read_u16_d16_hi v146, v193 offset:24576
    ds_read_u16_d16_hi v147, v193 offset:57344
    ds_read_u16_d16_hi v148, v192 offset:25600
    ds_read_u16_d16_hi v149, v192 offset:58368
    ds_read_u16_d16_hi v150, v193 offset:25600
    ds_read_u16_d16_hi v151, v193 offset:58368
    v_pk_add_f32 v[64:65], v[128:129], v[130:131] neg_hi:[0,1]
    v_pk_add_f32 v[66:67], v[128:129], v[130:131] op_sel:[1,1] op_sel_hi:[0,0] neg_hi:[1,0]
    v_pk_mul_f32 v[64:65], v[64:65], v[196:197] op_sel:[0,1] op_sel_hi:[1,1]
    v_pk_mul_f32 v[66:67], v[66:67], v[198:199] op_sel_hi:[1,0]
    v_pk_add_f32 v[68:69], v[132:133], v[134:135] neg_hi:[0,1]
    v_pk_add_f32 v[70:71], v[132:133], v[134:135] op_sel:[1,1] op_sel_hi:[0,0] neg_hi:[1,0]
    v_pk_mul_f32 v[68:69], v[68:69], v[196:197] op_sel:[0,1] op_sel_hi:[1,1]
    v_pk_mul_f32 v[70:71], v[70:71], v[198:199] op_sel_hi:[1,0]
    v_pk_add_f32 v[72:73], v[136:137], v[138:139] neg_hi:[0,1]
    v_pk_add_f32 v[74:75], v[136:137], v[138:139] op_sel:[1,1] op_sel_hi:[0,0] neg_hi:[1,0]
    v_pk_mul_f32 v[72:73], v[72:73], v[196:197] op_sel:[0,1] op_sel_hi:[1,1]
    v_pk_mul_f32 v[74:75], v[74:75], v[198:199] op_sel_hi:[1,0]
    s_waitcnt lgkmcnt(0)
    ds_read_u16_d16_hi v128, v192 offset:28672
    s_nop 0
    ds_read_u16_d16_hi v129, v192 offset:61440
    ds_read_u16_d16_hi v130, v193 offset:28672
    ds_read_u16_d16_hi v131, v193 offset:61440
    ds_read_u16_d16_hi v132, v192 offset:29696
    ds_read_u16_d16_hi v133, v192 offset:62464
    ds_read_u16_d16_hi v134, v193 offset:29696
    ds_read_u16_d16_hi v135, v193 offset:62464
    v_pk_add_f32 v[76:77], v[140:141], v[142:143] neg_hi:[0,1]
    v_pk_add_f32 v[78:79], v[140:141], v[142:143] op_sel:[1,1] op_sel_hi:[0,0] neg_hi:[1,0]
    v_pk_mul_f32 v[76:77], v[76:77], v[196:197] op_sel:[0,1] op_sel_hi:[1,1]
    v_pk_mul_f32 v[78:79], v[78:79], v[198:199] op_sel_hi:[1,0]
    v_pk_add_f32 v[80:81], v[144:145], v[146:147] neg_hi:[0,1]
    v_pk_add_f32 v[82:83], v[144:145], v[146:147] op_sel:[1,1] op_sel_hi:[0,0] neg_hi:[1,0]
    v_pk_mul_f32 v[80:81], v[80:81], v[196:197] op_sel:[0,1] op_sel_hi:[1,1]
    v_pk_mul_f32 v[82:83], v[82:83], v[198:199] op_sel_hi:[1,0]
    v_pk_add_f32 v[84:85], v[148:149], v[150:151] neg_hi:[0,1]
    v_pk_add_f32 v[86:87], v[148:149], v[150:151] op_sel:[1,1] op_sel_hi:[0,0] neg_hi:[1,0]
    v_pk_mul_f32 v[84:85], v[84:85], v[196:197] op_sel:[0,1] op_sel_hi:[1,1]
    v_pk_mul_f32 v[86:87], v[86:87], v[198:199] op_sel_hi:[1,0]
    s_waitcnt lgkmcnt(0)
    s_nop 0
    v_pk_add_f32 v[88:89], v[128:129], v[130:131] neg_hi:[0,1]
    v_pk_add_f32 v[90:91], v[128:129], v[130:131] op_sel:[1,1] op_sel_hi:[0,0] neg_hi:[1,0]
    v_pk_mul_f32 v[88:89], v[88:89], v[196:197] op_sel:[0,1] op_sel_hi:[1,1]
    v_pk_mul_f32 v[90:91], v[90:91], v[198:199] op_sel_hi:[1,0]
    v_pk_add_f32 v[92:93], v[132:133], v[134:135] neg_hi:[0,1]
    v_pk_add_f32 v[94:95], v[132:133], v[134:135] op_sel:[1,1] op_sel_hi:[0,0] neg_hi:[1,0]
    v_pk_mul_f32 v[92:93], v[92:93], v[196:197] op_sel:[0,1] op_sel_hi:[1,1]
    v_pk_mul_f32 v[94:95], v[94:95], v[198:199] op_sel_hi:[1,0]
    v_pk_mov_b32 v[18:19], v[20:21], v[20:21] op_sel:[0,1]
    s_cmp_eq_u32 s3, 3
    s_cbranch_scc1 L_keepd
    v_pk_mov_b32 v[18:19], v[14:15], v[14:15] op_sel:[0,1]
    v_pk_mov_b32 v[96:97], v[32:33], v[32:33] op_sel:[0,1]
    v_pk_mov_b32 v[98:99], v[36:37], v[36:37] op_sel:[0,1]
    v_pk_mov_b32 v[100:101], v[40:41], v[40:41] op_sel:[0,1]
    v_pk_mov_b32 v[102:103], v[44:45], v[44:45] op_sel:[0,1]
    v_pk_mov_b32 v[104:105], v[48:49], v[48:49] op_sel:[0,1]
    v_pk_mov_b32 v[106:107], v[52:53], v[52:53] op_sel:[0,1]
    v_pk_mov_b32 v[108:109], v[56:57], v[56:57] op_sel:[0,1]
    v_pk_mov_b32 v[110:111], v[60:61], v[60:61] op_sel:[0,1]
    v_pk_mov_b32 v[112:113], v[64:65], v[64:65] op_sel:[0,1]
    v_pk_mov_b32 v[114:115], v[68:69], v[68:69] op_sel:[0,1]
    v_pk_mov_b32 v[116:117], v[72:73], v[72:73] op_sel:[0,1]
    v_pk_mov_b32 v[118:119], v[76:77], v[76:77] op_sel:[0,1]
    v_pk_mov_b32 v[120:121], v[80:81], v[80:81] op_sel:[0,1]
    v_pk_mov_b32 v[122:123], v[84:85], v[84:85] op_sel:[0,1]
    v_pk_mov_b32 v[124:125], v[88:89], v[88:89] op_sel:[0,1]
    v_pk_mov_b32 v[126:127], v[92:93], v[92:93] op_sel:[0,1]
L_keepd:
    s_add_u32 s30, s30, 14
    s_cmp_lg_u32 s3, 3
    s_cbranch_scc1 L_qgo
    s_mov_b64 exec, s[48:49]
    s_mov_b32 s66, 2000000
L_can:
    s_sub_u32 s66, s66, 1
    s_cbranch_scc1 L_can_out
    v_mov_b32_e64 v5, 0
    buffer_atomic_add v5, v9, s[20:23], s54 offen sc0
    s_waitcnt vmcnt(0)
    v_cmp_ne_u32 vcc, s30, v5
    s_nop 0
    s_and_b64 exec, vcc, exec
    s_cbranch_scc0 L_can_out
    s_bcnt1_i32_b64 s60, exec
    s_cmp_lt_u32 s60, 18
    s_cbranch_scc1 L_can
    s_sleep 10
    s_branch L_can
L_can_out:
    s_mov_b64 exec, -1
L_qgo:
    s_barrier
    s_add_u32 m0, s34, 0
    s_add_u32 s35, s52, 0
    buffer_load_dwordx4 v24, s[20:23], s35 offen offset:0 sc1 lds
    buffer_load_dwordx4 v24, s[20:23], s35 offen offset:1024 sc1 lds
    buffer_load_dwordx4 v24, s[20:23], s35 offen offset:2048 sc1 lds
    buffer_load_dwordx4 v24, s[20:23], s35 offen offset:3072 sc1 lds
    s_add_u32 m0, s34, 4096
    s_add_u32 s35, s52, 4096
    buffer_load_dwordx4 v24, s[20:23], s35 offen offset:0 sc1 lds
    buffer_load_dwordx4 v24, s[20:23], s35 offen offset:1024 sc1 lds
    buffer_load_dwordx4 v24, s[20:23], s35 offen offset:2048 sc1 lds
    buffer_load_dwordx4 v24, s[20:23], s35 offen offset:3072 sc1 lds
    s_add_u32 m0, s34, 8192
    s_add_u32 s35, s53, 0
    s_nop 0
    buffer_load_dwordx4 v24, s[20:23], s35 offen offset:0 sc1 lds
    buffer_load_dwordx4 v24, s[20:23], s35 offen offset:1024 sc1 lds
    buffer_load_dwordx4 v24, s[20:23], s35 offen offset:2048 sc1 lds
    buffer_load_dwordx4 v24, s[20:23], s35 offen offset:3072 sc1 lds
    s_add_u32 m0, s34, 12288
    s_add_u32 s35, s53, 4096
    buffer_load_dwordx4 v24, s[20:23], s35 offen offset:0 sc1 lds
    buffer_load_dwordx4 v24, s[20:23], s35 offen offset:1024 sc1 lds
    buffer_load_dwordx4 v24, s[20:23], s35 offen offset:2048 sc1 lds
    buffer_load_dwordx4 v24, s[20:23], s35 offen offset:3072 sc1 lds
    s_mov_b32 s57, s56
    s_mov_b32 s55, 1
    s_waitcnt lgkmcnt(0)
.p2alignl 5, 0xbf800000
L_body:
    s_waitcnt vmcnt(12)
    ds_read2st64_b32 a[64:65], v8 offset0:0 offset1:1
    ds_read2st64_b32 a[66:67], v25 offset0:0 offset1:1
    ds_read2st64_b32 a[68:69], v8 offset0:4 offset1:5
    s_nop 0
    ds_read2st64_b32 a[70:71], v25 offset0:4 offset1:5
    ds_read2st64_b32 a[72:73], v8 offset0:8 offset1:9
    ds_read2st64_b32 a[74:75], v25 offset0:8 offset1:9
    ds_read2st64_b32 a[76:77], v8 offset0:12 offset1:13
    ds_read2st64_b32 a[78:79], v25 offset0:12 offset1:13
    s_waitcnt lgkmcnt(6)
    v_mfma_f32_32x32x16_bf16 v[128:143], a[0:3], a[64:67], 0
    s_waitcnt lgkmcnt(4)
    v_mfma_f32_32x32x16_bf16 v[128:143], a[4:7], a[68:71], v[128:143]
    s_waitcnt lgkmcnt(2)
    v_mfma_f32_32x32x16_bf16 v[128:143], a[8:11], a[72:75], v[128:143]
    s_waitcnt lgkmcnt(0)
    v_mfma_f32_32x32x16_bf16 v[128:143], a[12:15], a[76:79], v[128:143]
    v_mfma_f32_32x32x16_bf16 v[144:159], a[16:19], a[64:67], 0
    s_waitcnt vmcnt(8)
    ds_read2st64_b32 a[80:81], v8 offset0:16 offset1:17
    ds_read2st64_b32 a[82:83], v25 offset0:16 offset1:17
    ds_read2st64_b32 a[84:85], v8 offset0:20 offset1:21
    s_nop 0
    ds_read2st64_b32 a[86:87], v25 offset0:20 offset1:21
    ds_read2st64_b32 a[88:89], v8 offset0:24 offset1:25
    v_mfma_f32_32x32x16_bf16 v[144:159], a[20:23], a[68:71], v[144:159]
    ds_read2st64_b32 a[90:91], v25 offset0:24 offset1:25
    ds_read2st64_b32 a[92:93], v8 offset0:28 offset1:29
    ds_read2st64_b32 a[94:95], v25 offset0:28 offset1:29
    v_mfma_f32_32x32x16_bf16 v[144:159], a[24:27], a[72:75], v[144:159]
    v_mfma_f32_32x32x16_bf16 v[144:159], a[28:31], a[76:79], v[144:159]
    s_waitcnt lgkmcnt(6)
    v_mfma_f32_32x32x16_bf16 v[160:175], a[0:3], a[80:83], 0
    s_waitcnt lgkmcnt(4)
    v_mfma_f32_32x32x16_bf16 v[160:175], a[4:7], a[84:87], v[160:175]
    s_waitcnt lgkmcnt(2)
    v_mfma_f32_32x32x16_bf16 v[160:175], a[8:11], a[88:91], v[160:175]
    s_waitcnt lgkmcnt(0)
    v_mfma_f32_32x32x16_bf16 v[160:175], a[12:15], a[92:95], v[160:175]
    v_mfma_f32_32x32x16_bf16 v[176:191], a[16:19], a[80:83], 0
    v_mfma_f32_32x32x16_bf16 v[176:191], a[20:23], a[84:87], v[176:191]
    v_mfma_f32_32x32x16_bf16 v[176:191], a[24:27], a[88:91], v[176:191]
    v_mfma_f32_32x32x16_bf16 v[176:191], a[28:31], a[92:95], v[176:191]
    v_pk_mul_f32 v[2:3], v[128:129], v[14:15]
    v_pk_mul_f32 v[4:5], v[128:129], v[16:17]
    v_pk_fma_f32 v[2:3], v[128:129], v[32:33], v[2:3] op_sel:[1,1,0] op_sel_hi:[0,1,1] neg_lo:[1,0,0]
    v_pk_fma_f32 v[4:5], v[128:129], v[34:35], v[4:5] op_sel:[1,1,0] op_sel_hi:[0,1,1] neg_lo:[1,0,0]
    s_nop 3
    v_pk_fma_f32 v[2:3], v[160:161], v[16:17], v[2:3] neg_lo:[1,0,0] neg_hi:[1,0,0]
    s_nop 0
    v_pk_fma_f32 v[4:5], v[160:161], v[18:19], v[4:5]
    v_pk_fma_f32 v[2:3], v[160:161], v[34:35], v[2:3] op_sel:[1,1,0] op_sel_hi:[0,1,1] neg_hi:[1,0,0]
    v_pk_fma_f32 v[4:5], v[160:161], v[96:97], v[4:5] op_sel:[1,1,0] op_sel_hi:[0,1,1] neg_lo:[1,0,0]
    v_cvt_pk_bf16_f32 v128, v2, v3
    v_cvt_pk_bf16_f32 v160, v4, v5
    v_pk_mul_f32 v[6:7], v[130:131], v[36:37] op_sel_hi:[1,0]
    v_pk_mul_f32 v[30:31], v[130:131], v[38:39] op_sel_hi:[1,0]
    v_pk_fma_f32 v[6:7], v[130:131], v[36:37], v[6:7] op_sel:[1,1,0] op_sel_hi:[0,1,1] neg_lo:[1,0,0]
    v_pk_fma_f32 v[30:31], v[130:131], v[38:39], v[30:31] op_sel:[1,1,0] op_sel_hi:[0,1,1] neg_lo:[1,0,0]
    v_pk_fma_f32 v[6:7], v[162:163], v[38:39], v[6:7] op_sel_hi:[1,0,1] neg_lo:[1,0,0] neg_hi:[1,0,0]
    v_pk_fma_f32 v[30:31], v[162:163], v[98:99], v[30:31] op_sel_hi:[1,0,1]
    v_pk_fma_f32 v[6:7], v[162:163], v[38:39], v[6:7] op_sel:[1,1,0] op_sel_hi:[0,1,1] neg_hi:[1,0,0]
    v_pk_fma_f32 v[30:31], v[162:163], v[98:99], v[30:31] op_sel:[1,1,0] op_sel_hi:[0,1,1] neg_lo:[1,0,0]
    v_cvt_pk_bf16_f32 v129, v6, v7
    v_cvt_pk_bf16_f32 v161, v30, v31
    v_pk_mul_f32 v[2:3], v[132:133], v[40:41] op_sel_hi:[1,0]
    v_pk_mul_f32 v[4:5], v[132:133], v[42:43] op_sel_hi:[1,0]
    v_pk_fma_f32 v[2:3], v[132:133], v[40:41], v[2:3] op_sel:[1,1,0] op_sel_hi:[0,1,1] neg_lo:[1,0,0]
    v_pk_fma_f32 v[4:5], v[132:133], v[42:43], v[4:5] op_sel:[1,1,0] op_sel_hi:[0,1,1] neg_lo:[1,0,0]
    v_pk_fma_f32 v[2:3], v[164:165], v[42:43], v[2:3] op_sel_hi:[1,0,1] neg_lo:[1,0,0] neg_hi:[1,0,0]
    v_pk_fma_f32 v[4:5], v[164:165], v[100:101], v[4:5] op_sel_hi:[1,0,1]
    v_pk_fma_f32 v[2:3], v[164:165], v[42:43], v[2:3] op_sel:[1,1,0] op_sel_hi:[0,1,1] neg_hi:[1,0,0]
    v_pk_fma_f32 v[4:5], v[164:165], v[100:101], v[4:5] op_sel:[1,1,0] op_sel_hi:[0,1,1] neg_lo:[1,0,0]
    v_cvt_pk_bf16_f32 v130, v2, v3
    v_cvt_pk_bf16_f32 v162, v4, v5
    v_pk_mul_f32 v[6:7], v[134:135], v[44:45] op_sel_hi:[1,0]
    v_pk_mul_f32 v[30:31], v[134:135], v[46:47] op_sel_hi:[1,0]
    v_pk_fma_f32 v[6:7], v[134:135], v[44:45], v[6:7] op_sel:[1,1,0] op_sel_hi:[0,1,1] neg_lo:[1,0,0]
    v_pk_fma_f32 v[30:31], v[134:135], v[46:47], v[30:31] op_sel:[1,1,0] op_sel_hi:[0,1,1] neg_lo:[1,0,0]
    v_pk_fma_f32 v[6:7], v[166:167], v[46:47], v[6:7] op_sel_hi:[1,0,1] neg_lo:[1,0,0] neg_hi:[1,0,0]
    v_pk_fma_f32 v[30:31], v[166:167], v[102:103], v[30:31] op_sel_hi:[1,0,1]
    v_pk_fma_f32 v[6:7], v[166:167], v[46:47], v[6:7] op_sel:[1,1,0] op_sel_hi:[0,1,1] neg_hi:[1,0,0]
    v_pk_fma_f32 v[30:31], v[166:167], v[102:103], v[30:31] op_sel:[1,1,0] op_sel_hi:[0,1,1] neg_lo:[1,0,0]
    v_cvt_pk_bf16_f32 v131, v6, v7
    v_cvt_pk_bf16_f32 v163, v30, v31
    v_pk_mul_f32 v[2:3], v[136:137], v[48:49] op_sel_hi:[1,0]
    v_pk_mul_f32 v[4:5], v[136:137], v[50:51] op_sel_hi:[1,0]
    v_pk_fma_f32 v[2:3], v[136:137], v[48:49], v[2:3] op_sel:[1,1,0] op_sel_hi:[0,1,1] neg_lo:[1,0,0]
    v_pk_fma_f32 v[4:5], v[136:137], v[50:51], v[4:5] op_sel:[1,1,0] op_sel_hi:[0,1,1] neg_lo:[1,0,0]
    v_pk_fma_f32 v[2:3], v[168:169], v[50:51], v[2:3] op_sel_hi:[1,0,1] neg_lo:[1,0,0] neg_hi:[1,0,0]
    v_pk_fma_f32 v[4:5], v[168:169], v[104:105], v[4:5] op_sel_hi:[1,0,1]
    v_pk_fma_f32 v[2:3], v[168:169], v[50:51], v[2:3] op_sel:[1,1,0] op_sel_hi:[0,1,1] neg_hi:[1,0,0]
    v_pk_fma_f32 v[4:5], v[168:169], v[104:105], v[4:5] op_sel:[1,1,0] op_sel_hi:[0,1,1] neg_lo:[1,0,0]
    v_cvt_pk_bf16_f32 v132, v2, v3
    v_cvt_pk_bf16_f32 v164, v4, v5
    v_pk_mul_f32 v[6:7], v[138:139], v[52:53] op_sel_hi:[1,0]
    v_pk_mul_f32 v[30:31], v[138:139], v[54:55] op_sel_hi:[1,0]
    v_pk_fma_f32 v[6:7], v[138:139], v[52:53], v[6:7] op_sel:[1,1,0] op_sel_hi:[0,1,1] neg_lo:[1,0,0]
    v_pk_fma_f32 v[30:31], v[138:139], v[54:55], v[30:31] op_sel:[1,1,0] op_sel_hi:[0,1,1] neg_lo:[1,0,0]
    v_pk_fma_f32 v[6:7], v[170:171], v[54:55], v[6:7] op_sel_hi:[1,0,1] neg_lo:[1,0,0] neg_hi:[1,0,0]
    v_pk_fma_f32 v[30:31], v[170:171], v[106:107], v[30:31] op_sel_hi:[1,0,1]
    v_pk_fma_f32 v[6:7], v[170:171], v[54:55], v[6:7] op_sel:[1,1,0] op_sel_hi:[0,1,1] neg_hi:[1,0,0]
    v_pk_fma_f32 v[30:31], v[170:171], v[106:107], v[30:31] op_sel:[1,1,0] op_sel_hi:[0,1,1] neg_lo:[1,0,0]
    v_cvt_pk_bf16_f32 v133, v6, v7
    v_cvt_pk_bf16_f32 v165, v30, v31
    s_waitcnt vmcnt(0)
    s_barrier
    s_lshl2_add_u32 s60, s3, s55
    s_cmp_lg_u32 s60, 2
    s_cbranch_scc1 L_noza
    s_mov_b32 exec_lo, 0x55555555
    s_mov_b32 exec_hi, 0
    buffer_atomic_add v26, v9, s[20:23], s59 offen
    s_mov_b64 exec, -1
L_noza:
    v_pk_mul_f32 v[2:3], v[140:141], v[56:57] op_sel_hi:[1,0]
    v_pk_mul_f32 v[4:5], v[140:141], v[58:59] op_sel_hi:[1,0]
    v_pk_fma_f32 v[2:3], v[140:141], v[56:57], v[2:3] op_sel:[1,1,0] op_sel_hi:[0,1,1] neg_lo:[1,0,0]
    s_nop 0
    v_pk_fma_f32 v[4:5], v[140:141], v[58:59], v[4:5] op_sel:[1,1,0] op_sel_hi:[0,1,1] neg_lo:[1,0,0]
    v_pk_fma_f32 v[2:3], v[172:173], v[58:59], v[2:3] op_sel_hi:[1,0,1] neg_lo:[1,0,0] neg_hi:[1,0,0]
    v_pk_fma_f32 v[4:5], v[172:173], v[108:109], v[4:5] op_sel_hi:[1,0,1]
    v_pk_fma_f32 v[2:3], v[172:173], v[58:59], v[2:3] op_sel:[1,1,0] op_sel_hi:[0,1,1] neg_hi:[1,0,0]
    v_pk_fma_f32 v[4:5], v[172:173], v[108:109], v[4:5] op_sel:[1,1,0] op_sel_hi:[0,1,1] neg_lo:[1,0,0]
    v_cvt_pk_bf16_f32 v134, v2, v3
    v_cvt_pk_bf16_f32 v166, v4, v5
    v_pk_mul_f32 v[6:7], v[142:143], v[60:61] op_sel_hi:[1,0]
    v_pk_mul_f32 v[30:31], v[142:143], v[62:63] op_sel_hi:[1,0]
    v_pk_fma_f32 v[6:7], v[142:143], v[60:61], v[6:7] op_sel:[1,1,0] op_sel_hi:[0,1,1] neg_lo:[1,0,0]
    v_pk_fma_f32 v[30:31], v[142:143], v[62:63], v[30:31] op_sel:[1,1,0] op_sel_hi:[0,1,1] neg_lo:[1,0,0]
    v_pk_fma_f32 v[6:7], v[174:175], v[62:63], v[6:7] op_sel_hi:[1,0,1] neg_lo:[1,0,0] neg_hi:[1,0,0]
    v_pk_fma_f32 v[30:31], v[174:175], v[110:111], v[30:31] op_sel_hi:[1,0,1]
    v_pk_fma_f32 v[6:7], v[174:175], v[62:63], v[6:7] op_sel:[1,1,0] op_sel_hi:[0,1,1] neg_hi:[1,0,0]
    v_pk_fma_f32 v[30:31], v[174:175], v[110:111], v[30:31] op_sel:[1,1,0] op_sel_hi:[0,1,1] neg_lo:[1,0,0]
    v_cvt_pk_bf16_f32 v135, v6, v7
    v_cvt_pk_bf16_f32 v167, v30, v31
    v_pk_mul_f32 v[2:3], v[144:145], v[64:65] op_sel_hi:[1,0]
    v_pk_mul_f32 v[4:5], v[144:145], v[66:67] op_sel_hi:[1,0]
    v_pk_fma_f32 v[2:3], v[144:145], v[64:65], v[2:3] op_sel:[1,1,0] op_sel_hi:[0,1,1] neg_lo:[1,0,0]
L_padf1:
    s_cbranch_execz L_padf5
    v_pk_fma_f32 v[4:5], v[144:145], v[66:67], v[4:5] op_sel:[1,1,0] op_sel_hi:[0,1,1] neg_lo:[1,0,0]
    v_pk_fma_f32 v[2:3], v[176:177], v[66:67], v[2:3] op_sel_hi:[1,0,1] neg_lo:[1,0,0] neg_hi:[1,0,0]
    v_pk_fma_f32 v[4:5], v[176:177], v[112:113], v[4:5] op_sel_hi:[1,0,1]
    s_nop 0
    v_pk_fma_f32 v[2:3], v[176:177], v[66:67], v[2:3] op_sel:[1,1,0] op_sel_hi:[0,1,1] neg_hi:[1,0,0]
    v_pk_fma_f32 v[4:5], v[176:177], v[112:113], v[4:5] op_sel:[1,1,0] op_sel_hi:[0,1,1] neg_lo:[1,0,0]
    v_cvt_pk_bf16_f32 v136, v2, v3
    v_cvt_pk_bf16_f32 v168, v4, v5
    v_pk_mul_f32 v[6:7], v[146:147], v[68:69] op_sel_hi:[1,0]
    v_pk_mul_f32 v[30:31], v[146:147], v[70:71] op_sel_hi:[1,0]
    v_pk_fma_f32 v[6:7], v[146:147], v[68:69], v[6:7] op_sel:[1,1,0] op_sel_hi:[0,1,1] neg_lo:[1,0,0]
    v_pk_fma_f32 v[30:31], v[146:147], v[70:71], v[30:31] op_sel:[1,1,0] op_sel_hi:[0,1,1] neg_lo:[1,0,0]
    v_pk_fma_f32 v[6:7], v[178:179], v[70:71], v[6:7] op_sel_hi:[1,0,1] neg_lo:[1,0,0] neg_hi:[1,0,0]
    v_pk_fma_f32 v[30:31], v[178:179], v[114:115], v[30:31] op_sel_hi:[1,0,1]
    v_pk_fma_f32 v[6:7], v[178:179], v[70:71], v[6:7] op_sel:[1,1,0] op_sel_hi:[0,1,1] neg_hi:[1,0,0]
    v_pk_fma_f32 v[30:31], v[178:179], v[114:115], v[30:31] op_sel:[1,1,0] op_sel_hi:[0,1,1] neg_lo:[1,0,0]
    v_cvt_pk_bf16_f32 v137, v6, v7
    v_cvt_pk_bf16_f32 v169, v30, v31
    v_pk_mul_f32 v[2:3], v[148:149], v[72:73] op_sel_hi:[1,0]
    v_pk_mul_f32 v[4:5], v[148:149], v[74:75] op_sel_hi:[1,0]
    v_pk_fma_f32 v[2:3], v[148:149], v[72:73], v[2:3] op_sel:[1,1,0] op_sel_hi:[0,1,1] neg_lo:[1,0,0]
    v_pk_fma_f32 v[4:5], v[148:149], v[74:75], v[4:5] op_sel:[1,1,0] op_sel_hi:[0,1,1] neg_lo:[1,0,0]
    v_pk_fma_f32 v[2:3], v[180:181], v[74:75], v[2:3] op_sel_hi:[1,0,1] neg_lo:[1,0,0] neg_hi:[1,0,0]
    v_pk_fma_f32 v[4:5], v[180:181], v[116:117], v[4:5] op_sel_hi:[1,0,1]
    v_pk_fma_f32 v[2:3], v[180:181], v[74:75], v[2:3] op_sel:[1,1,0] op_sel_hi:[0,1,1] neg_hi:[1,0,0]
    v_pk_fma_f32 v[4:5], v[180:181], v[116:117], v[4:5] op_sel:[1,1,0] op_sel_hi:[0,1,1] neg_lo:[1,0,0]
    v_cvt_pk_bf16_f32 v138, v2, v3
    v_cvt_pk_bf16_f32 v170, v4, v5
    v_pk_mul_f32 v[6:7], v[150:151], v[76:77] op_sel_hi:[1,0]
    v_pk_mul_f32 v[30:31], v[150:151], v[78:79] op_sel_hi:[1,0]
    v_pk_fma_f32 v[6:7], v[150:151], v[76:77], v[6:7] op_sel:[1,1,0] op_sel_hi:[0,1,1] neg_lo:[1,0,0]
    v_pk_fma_f32 v[30:31], v[150:151], v[78:79], v[30:31] op_sel:[1,1,0] op_sel_hi:[0,1,1] neg_lo:[1,0,0]
    v_pk_fma_f32 v[6:7], v[182:183], v[78:79], v[6:7] op_sel_hi:[1,0,1] neg_lo:[1,0,0] neg_hi:[1,0,0]
    v_pk_fma_f32 v[30:31], v[182:183], v[118:119], v[30:31] op_sel_hi:[1,0,1]
    v_pk_fma_f32 v[6:7], v[182:183], v[78:79], v[6:7] op_sel:[1,1,0] op_sel_hi:[0,1,1] neg_hi:[1,0,0]
    v_pk_fma_f32 v[30:31], v[182:183], v[118:119], v[30:31] op_sel:[1,1,0] op_sel_hi:[0,1,1] neg_lo:[1,0,0]
    v_cvt_pk_bf16_f32 v139, v6, v7
    v_cvt_pk_bf16_f32 v171, v30, v31
    v_pk_mul_f32 v[2:3], v[152:153], v[80:81] op_sel_hi:[1,0]
    v_pk_mul_f32 v[4:5], v[152:153], v[82:83] op_sel_hi:[1,0]
    v_pk_fma_f32 v[2:3], v[152:153], v[80:81], v[2:3] op_sel:[1,1,0] op_sel_hi:[0,1,1] neg_lo:[1,0,0]
    v_pk_fma_f32 v[4:5], v[152:153], v[82:83], v[4:5] op_sel:[1,1,0] op_sel_hi:[0,1,1] neg_lo:[1,0,0]
    v_pk_fma_f32 v[2:3], v[184:185], v[82:83], v[2:3] op_sel_hi:[1,0,1] neg_lo:[1,0,0] neg_hi:[1,0,0]
    v_pk_fma_f32 v[4:5], v[184:185], v[120:121], v[4:5] op_sel_hi:[1,0,1]
    v_pk_fma_f32 v[2:3], v[184:185], v[82:83], v[2:3] op_sel:[1,1,0] op_sel_hi:[0,1,1] neg_hi:[1,0,0]
    v_pk_fma_f32 v[4:5], v[184:185], v[120:121], v[4:5] op_sel:[1,1,0] op_sel_hi:[0,1,1] neg_lo:[1,0,0]
    v_cvt_pk_bf16_f32 v140, v2, v3
    v_cvt_pk_bf16_f32 v172, v4, v5
    v_pk_mul_f32 v[6:7], v[154:155], v[84:85] op_sel_hi:[1,0]
    v_pk_mul_f32 v[30:31], v[154:155], v[86:87] op_sel_hi:[1,0]
    v_pk_fma_f32 v[6:7], v[154:155], v[84:85], v[6:7] op_sel:[1,1,0] op_sel_hi:[0,1,1] neg_lo:[1,0,0]
    v_pk_fma_f32 v[30:31], v[154:155], v[86:87], v[30:31] op_sel:[1,1,0] op_sel_hi:[0,1,1] neg_lo:[1,0,0]
    v_pk_fma_f32 v[6:7], v[186:187], v[86:87], v[6:7] op_sel_hi:[1,0,1] neg_lo:[1,0,0] neg_hi:[1,0,0]
    v_pk_fma_f32 v[30:31], v[186:187], v[122:123], v[30:31] op_sel_hi:[1,0,1]
    v_pk_fma_f32 v[6:7], v[186:187], v[86:87], v[6:7] op_sel:[1,1,0] op_sel_hi:[0,1,1] neg_hi:[1,0,0]
    v_pk_fma_f32 v[30:31], v[186:187], v[122:123], v[30:31] op_sel:[1,1,0] op_sel_hi:[0,1,1] neg_lo:[1,0,0]
    v_cvt_pk_bf16_f32 v141, v6, v7
    v_cvt_pk_bf16_f32 v173, v30, v31
    v_pk_mul_f32 v[2:3], v[156:157], v[88:89] op_sel_hi:[1,0]
    v_pk_mul_f32 v[4:5], v[156:157], v[90:91] op_sel_hi:[1,0]
    v_pk_fma_f32 v[2:3], v[156:157], v[88:89], v[2:3] op_sel:[1,1,0] op_sel_hi:[0,1,1] neg_lo:[1,0,0]
    v_pk_fma_f32 v[4:5], v[156:157], v[90:91], v[4:5] op_sel:[1,1,0] op_sel_hi:[0,1,1] neg_lo:[1,0,0]
    v_pk_fma_f32 v[2:3], v[188:189], v[90:91], v[2:3] op_sel_hi:[1,0,1] neg_lo:[1,0,0] neg_hi:[1,0,0]
    v_pk_fma_f32 v[4:5], v[188:189], v[124:125], v[4:5] op_sel_hi:[1,0,1]
    v_pk_fma_f32 v[2:3], v[188:189], v[90:91], v[2:3] op_sel:[1,1,0] op_sel_hi:[0,1,1] neg_hi:[1,0,0]
    v_pk_fma_f32 v[4:5], v[188:189], v[124:125], v[4:5] op_sel:[1,1,0] op_sel_hi:[0,1,1] neg_lo:[1,0,0]
    v_cvt_pk_bf16_f32 v142, v2, v3
    v_cvt_pk_bf16_f32 v174, v4, v5
    v_pk_mul_f32 v[6:7], v[158:159], v[92:93] op_sel_hi:[1,0]
    v_pk_mul_f32 v[30:31], v[158:159], v[94:95] op_sel_hi:[1,0]
    v_pk_fma_f32 v[6:7], v[158:159], v[92:93], v[6:7] op_sel:[1,1,0] op_sel_hi:[0,1,1] neg_lo:[1,0,0]
    v_pk_fma_f32 v[30:31], v[158:159], v[94:95], v[30:31] op_sel:[1,1,0] op_sel_hi:[0,1,1] neg_lo:[1,0,0]
    v_pk_fma_f32 v[6:7], v[190:191], v[94:95], v[6:7] op_sel_hi:[1,0,1] neg_lo:[1,0,0] neg_hi:[1,0,0]
    v_pk_fma_f32 v[30:31], v[190:191], v[126:127], v[30:31] op_sel_hi:[1,0,1]
    v_pk_fma_f32 v[6:7], v[190:191], v[94:95], v[6:7] op_sel:[1,1,0] op_sel_hi:[0,1,1] neg_hi:[1,0,0]
    v_pk_fma_f32 v[30:31], v[190:191], v[126:127], v[30:31] op_sel:[1,1,0] op_sel_hi:[0,1,1] neg_lo:[1,0,0]
    v_cvt_pk_bf16_f32 v143, v6, v7
    v_cvt_pk_bf16_f32 v175, v30, v31
    v_mfma_f32_32x32x16_bf16 v[192:207], v[128:131], a[32:35], 0
    ds_read2st64_b64 v[32:35], v28 offset0:0 offset1:1
    ds_read2st64_b64 v[36:39], v28 offset0:2 offset1:3
    ds_read2st64_b64 v[40:43], v28 offset0:4 offset1:5
    ds_read2st64_b64 v[44:47], v28 offset0:6 offset1:7
    ds_read2st64_b64 v[48:51], v28 offset0:8 offset1:9
    ds_read2st64_b64 v[52:55], v28 offset0:10 offset1:11
    v_mfma_f32_32x32x16_bf16 v[192:207], v[132:135], a[36:39], v[192:207]
    ds_read2st64_b64 v[56:59], v28 offset0:12 offset1:13
    ds_read2st64_b64 v[60:63], v28 offset0:14 offset1:15
    ds_read2st64_b64 v[64:67], v28 offset0:16 offset1:17
    ds_read2st64_b64 v[68:71], v28 offset0:18 offset1:19
    ds_read2st64_b64 v[72:75], v28 offset0:20 offset1:21
    ds_read2st64_b64 v[76:79], v28 offset0:22 offset1:23
    v_mfma_f32_32x32x16_bf16 v[192:207], v[136:139], a[40:43], v[192:207]
    ds_read2st64_b64 v[80:83], v28 offset0:24 offset1:25
    ds_read2st64_b64 v[84:87], v28 offset0:26 offset1:27
    ds_read2st64_b64 v[88:91], v28 offset0:28 offset1:29
    ds_read2st64_b64 v[92:95], v28 offset0:30 offset1:31
    v_mfma_f32_32x32x16_bf16 v[192:207], v[140:143], a[44:47], v[192:207]
    v_mfma_f32_32x32x16_bf16 v[208:223], v[128:131], a[48:51], 0
    v_mfma_f32_32x32x16_bf16 v[208:223], v[132:135], a[52:55], v[208:223]
    v_mfma_f32_32x32x16_bf16 v[208:223], v[136:139], a[56:59], v[208:223]
    s_nop 8
    v_cvt_pk_bf16_f32 v96, v192, v194
    v_cvt_pk_bf16_f32 v97, v196, v198
    s_nop 0
    v_cvt_pk_bf16_f32 v98, v200, v202
    v_cvt_pk_bf16_f32 v99, v204, v206
    v_mfma_f32_32x32x16_bf16 v[208:223], v[140:143], a[60:63], v[208:223]
    ds_write_b128 v11, v[96:99] offset:0
    v_mfma_f32_32x32x16_bf16 v[224:239], v[160:163], a[32:35], 0
    v_cvt_pk_bf16_f32 v100, v193, v195
    v_cvt_pk_bf16_f32 v101, v197, v199
    v_cvt_pk_bf16_f32 v102, v201, v203
    v_cvt_pk_bf16_f32 v103, v205, v207
    v_mfma_f32_32x32x16_bf16 v[224:239], v[164:167], a[36:39], v[224:239]
    ds_write_b128 v12, v[100:103] offset:0
    v_mfma_f32_32x32x16_bf16 v[224:239], v[168:171], a[40:43], v[224:239]
    ds_read_b128 v[104:107], v13 offset:0
    ds_read_b128 v[108:111], v13 offset:1024
    s_nop 0
    v_cvt_pk_bf16_f32 v112, v208, v210
    s_nop 0
    v_cvt_pk_bf16_f32 v113, v212, v214
    v_cvt_pk_bf16_f32 v114, v216, v218
    v_cvt_pk_bf16_f32 v115, v220, v222
    v_mfma_f32_32x32x16_bf16 v[224:239], v[172:175], a[44:47], v[224:239]
    ds_write_b128 v11, v[112:115] offset:2048
    v_mfma_f32_32x32x16_bf16 v[240:255], v[160:163], a[48:51], 0
    v_cvt_pk_bf16_f32 v116, v209, v211
    v_cvt_pk_bf16_f32 v117, v213, v215
    v_cvt_pk_bf16_f32 v118, v217, v219
    v_cvt_pk_bf16_f32 v119, v221, v223
    v_mfma_f32_32x32x16_bf16 v[240:255], v[164:167], a[52:55], v[240:255]
    ds_write_b128 v12, v[116:119] offset:2048
    v_mfma_f32_32x32x16_bf16 v[240:255], v[168:171], a[56:59], v[240:255]
    s_add_u32 s35, s57, 0
    s_waitcnt lgkmcnt(3)
    buffer_store_dwordx4 v[104:107], v10, s[20:23], s35 offen sc1
    s_add_u32 s35, s57, 458752
    v_mfma_f32_32x32x16_bf16 v[240:255], v[172:175], a[60:63], v[240:255]
    s_waitcnt lgkmcnt(2)
    buffer_store_dwordx4 v[108:111], v10, s[20:23], s35 offen sc1
    ds_read_b128 v[120:123], v13 offset:2048
    s_nop 0
    ds_read_b128 v[124:127], v13 offset:3072
    v_cvt_pk_bf16_f32 v96, v224, v226
    v_cvt_pk_bf16_f32 v97, v228, v230
    v_cvt_pk_bf16_f32 v98, v232, v234
    v_cvt_pk_bf16_f32 v99, v236, v238
    ds_write_b128 v11, v[96:99] offset:4096
    v_cvt_pk_bf16_f32 v100, v225, v227
    v_cvt_pk_bf16_f32 v101, v229, v231
    v_cvt_pk_bf16_f32 v102, v233, v235
    v_cvt_pk_bf16_f32 v103, v237, v239
    ds_write_b128 v12, v[100:103] offset:4096
    s_add_u32 s35, s57, 917504
    s_waitcnt lgkmcnt(3)
    buffer_store_dwordx4 v[120:123], v10, s[20:23], s35 offen sc1
    s_add_u32 s35, s57, 1376256
    s_waitcnt lgkmcnt(2)
    buffer_store_dwordx4 v[124:127], v10, s[20:23], s35 offen sc1
    ds_read_b128 v[104:107], v13 offset:4096
    ds_read_b128 v[108:111], v13 offset:5120
    v_cvt_pk_bf16_f32 v112, v240, v242
    v_cvt_pk_bf16_f32 v113, v244, v246
    v_cvt_pk_bf16_f32 v114, v248, v250
    v_cvt_pk_bf16_f32 v115, v252, v254
    ds_write_b128 v11, v[112:115] offset:6144
    v_cvt_pk_bf16_f32 v116, v241, v243
    v_cvt_pk_bf16_f32 v117, v245, v247
    v_cvt_pk_bf16_f32 v118, v249, v251
    v_cvt_pk_bf16_f32 v119, v253, v255
    ds_write_b128 v12, v[116:119] offset:6144
    s_add_u32 s35, s57, 14336
    s_waitcnt lgkmcnt(3)
    buffer_store_dwordx4 v[104:107], v10, s[20:23], s35 offen sc1
    s_add_u32 s35, s57, 473088
    s_waitcnt lgkmcnt(2)
    buffer_store_dwordx4 v[108:111], v10, s[20:23], s35 offen sc1
    ds_read_b128 v[120:123], v13 offset:6144
    ds_read_b128 v[124:127], v13 offset:7168
    s_add_u32 s35, s57, 931840
    s_waitcnt lgkmcnt(1)
    buffer_store_dwordx4 v[120:123], v10, s[20:23], s35 offen sc1
    s_add_u32 s35, s57, 1390592
    s_waitcnt lgkmcnt(0)
    buffer_store_dwordx4 v[124:127], v10, s[20:23], s35 offen sc1
    s_cmp_eq_u32 s55, 0
    s_cbranch_scc1 L_coef
    s_cmp_eq_u32 s55, 2
    s_cbranch_scc1 L_fin
    s_cmp_eq_u32 s3, 3
    s_cbranch_scc1 L_w3
    s_mov_b32 s55, 2
    s_nop 0
    s_add_u32 s57, s57, 6144
    v_add_u32 v8, 8192, v8
    v_add_u32 v25, 8192, v25
    v_pk_mov_b32 v[14:15], v[20:21], v[20:21] op_sel:[0,1]
    v_pk_mov_b32 v[16:17], v[22:23], v[22:23] op_sel:[0,1]
    v_pk_mov_b32 v[18:19], v[20:21], v[20:21] op_sel:[0,1]
    v_pk_mov_b32 v[96:97], v[32:33], v[32:33] op_sel:[0,1]
    v_pk_mov_b32 v[98:99], v[36:37], v[36:37] op_sel:[0,1]
    v_pk_mov_b32 v[100:101], v[40:41], v[40:41] op_sel:[0,1]
    v_pk_mov_b32 v[102:103], v[44:45], v[44:45] op_sel:[0,1]
    v_pk_mov_b32 v[104:105], v[48:49], v[48:49] op_sel:[0,1]
    v_pk_mov_b32 v[106:107], v[52:53], v[52:53] op_sel:[0,1]
    v_pk_mov_b32 v[108:109], v[56:57], v[56:57] op_sel:[0,1]
    v_pk_mov_b32 v[110:111], v[60:61], v[60:61] op_sel:[0,1]
    v_pk_mov_b32 v[112:113], v[64:65], v[64:65] op_sel:[0,1]
    v_pk_mov_b32 v[114:115], v[68:69], v[68:69] op_sel:[0,1]
    v_pk_mov_b32 v[116:117], v[72:73], v[72:73] op_sel:[0,1]
    v_pk_mov_b32 v[118:119], v[76:77], v[76:77] op_sel:[0,1]
    v_pk_mov_b32 v[120:121], v[80:81], v[80:81] op_sel:[0,1]
    v_pk_mov_b32 v[122:123], v[84:85], v[84:85] op_sel:[0,1]
    v_pk_mov_b32 v[124:125], v[88:89], v[88:89] op_sel:[0,1]
    v_pk_mov_b32 v[126:127], v[92:93], v[92:93] op_sel:[0,1]
    s_branch L_body
L_w3:
    s_waitcnt vmcnt(0)
    s_barrier
L_fin:
    s_waitcnt vmcnt(0)
    s_barrier
    s_cmp_lg_u32 s3, 0
    s_cbranch_scc1 L_zdone
    s_mov_b32 exec_lo, 0x55555555
    s_mov_b32 exec_hi, 0
    buffer_atomic_add v26, v9, s[20:23], s59 offen offset:256
    s_mov_b64 exec, -1
L_zdone:
    s_endpgm
L_slow0:
    s_waitcnt lgkmcnt(0)
    s_sub_u32 s44, s68, s30
    s_cmp_eq_u32 s44, 1
    s_cbranch_scc0 L_ag0
    s_sub_u32 s44, s69, s30
    s_cmp_eq_u32 s44, 1
    s_cbranch_scc0 L_ag0
    s_branch L_ok0
L_ag0:
    s_sub_u32 s68, 67584, s42
    v_min_u32 v11, 1, v0
    v_mul_lo_u32 v11, v11, s68
    v_add_u32 v11, s42, v11
    v_add_u32 v11, 135040, v11
L_vs0:
    s_sub_u32 s66, s66, 1
    s_cbranch_scc1 L_to0
    s_sleep 2
    buffer_load_dword v25, v11, s[20:23], 0 offen sc1
    s_waitcnt vmcnt(0)
    v_subrev_u32 v25, s30, v25
    v_cmp_ne_u32 s[68:69], 1, v25
    s_nop 0
    s_cmp_lg_u64 s[68:69], 0
    s_cbranch_scc1 L_vs0
    s_branch L_ok0
L_to0:
    s_mov_b32 s66, 0
    s_branch L_ok0
L_slow1:
    s_waitcnt lgkmcnt(0)
    s_sub_u32 s44, s69, s30
    s_cmp_eq_u32 s44, 28
    s_cbranch_scc0 L_ag1
    s_branch L_ok1
L_ag1:
    s_sub_u32 s66, s66, 1
    s_cbranch_scc1 L_to1
    s_sleep 2
    s_mov_b32 s69, 0
    s_atomic_add s69, s[20:21], s36 offset:198656 glc
    s_branch L_slow1
L_to1:
    s_mov_b32 s66, 0
    s_branch L_ok1
L_slow2:
    s_waitcnt lgkmcnt(0)
    s_sub_u32 s44, s68, s30
    s_cmp_eq_u32 s44, 14
    s_cbranch_scc0 L_ag2
    s_branch L_ok2
L_ag2:
    s_sub_u32 s66, s66, 1
    s_cbranch_scc1 L_to2
    s_mov_b32 s68, 0
    s_atomic_add s68, s[20:21], s62 offset:131072 glc
    s_branch L_slow2
L_to2:
    s_mov_b32 s66, 0
    s_branch L_ok2
L_slow3:
    s_waitcnt lgkmcnt(0)
    s_sub_u32 s44, s68, s30
    s_cmp_eq_u32 s44, 14
    s_cbranch_scc0 L_ag3
    s_branch L_ok3
L_ag3:
    s_sub_u32 s66, s66, 1
    s_cbranch_scc1 L_to3
    s_mov_b32 s68, 0
    s_atomic_add s68, s[20:21], s62 offset:131584 glc
    s_branch L_slow3
L_to3:
    s_mov_b32 s66, 0
    s_branch L_ok3
L_slow4:
    s_waitcnt lgkmcnt(0)
    s_sub_u32 s44, s69, s30
    s_cmp_eq_u32 s44, 16
    s_cbranch_scc0 L_ag4
    s_branch L_ok4
L_ag4:
    s_sub_u32 s66, s66, 1
    s_cbranch_scc1 L_to4
    s_sleep 2
    s_mov_b32 s69, 0
    s_atomic_add s69, s[20:21], s18 offset:133632 glc
    s_branch L_slow4
L_to4:
    s_mov_b32 s66, 0
    s_branch L_ok4
L_slow5:
    s_waitcnt lgkmcnt(0)
    s_sub_u32 s44, s68, s30
    s_cmp_eq_u32 s44, 14
    s_cbranch_scc0 L_ag5
    s_branch L_ok5
L_ag5:
    s_sub_u32 s66, s66, 1
    s_cbranch_scc1 L_to5
    s_mov_b32 s68, 0
    s_atomic_add s68, s[20:21], s62 offset:132096 glc
    s_branch L_slow5
L_to5:
    s_mov_b32 s66, 0
    s_branch L_ok5
L_slow6:
    s_waitcnt lgkmcnt(0)
    s_sub_u32 s44, s69, s30
    s_cmp_eq_u32 s44, 16
    s_cbranch_scc0 L_ag6
    s_branch L_ok6
L_ag6:
    s_sub_u32 s66, s66, 1
    s_cbranch_scc1 L_to6
    s_sleep 2
    s_mov_b32 s69, 0
    s_atomic_add s69, s[20:21], s18 offset:133888 glc
    s_branch L_slow6
L_to6:
    s_mov_b32 s66, 0
    s_branch L_ok6
L_slow7:
    s_waitcnt lgkmcnt(0)
    s_sub_u32 s44, s68, s30
    s_cmp_eq_u32 s44, 14
    s_cbranch_scc0 L_ag7
    s_branch L_ok7
L_ag7:
    s_sub_u32 s66, s66, 1
    s_cbranch_scc1 L_to7
    s_mov_b32 s68, 0
    s_atomic_add s68, s[20:21], s62 offset:132608 glc
    s_branch L_slow7
L_to7:
    s_mov_b32 s66, 0
    s_branch L_ok7
L_done:
    s_endpgm
.fill 64, 4, 0xbf800000
.section .rodata,"a"
.p2align 6
.amdhsa_kernel recurrent_scan__spectral_gfnet__glu_gated_glu__prompt_kernel
  .amdhsa_next_free_vgpr 512
  .amdhsa_next_free_sgpr 102
  .amdhsa_accum_offset 256
  .amdhsa_group_segment_fixed_size 0
  .amdhsa_kernarg_size 80
  .amdhsa_user_sgpr_count 2
  .amdhsa_user_sgpr_kernarg_segment_ptr 1
  .amdhsa_system_sgpr_workgroup_id_x 1
  .amdhsa_float_denorm_mode_32 3
.end_amdhsa_kernel
```
